```python
import torch

def _softmax(x, axis=-1):
    return torch.softmax(x, dim=axis)
def _gelu(x):
    return torch.nn.functional.gelu(x, approximate="tanh")
def _silu(x):
    return torch.nn.functional.silu(x)
def _sigmoid(x):
    return torch.sigmoid(x)
def _layernorm(x, axis=-1, eps=1e-5):
    m = x.mean(dim=axis, keepdim=True)
    v = x.var(dim=axis, keepdim=True, unbiased=False)
    return (x - m) / torch.sqrt(v + eps)
def _scatter_add(tgt, idx, src, axis=0):
    return tgt.clone().index_add_(axis, idx, src)
def _segment_sum(src, seg, n):
    out = torch.zeros((n,) + src.shape[1:], dtype=src.dtype)
    return out.index_add_(0, seg, src)
def _pad(x, pw):
    flat = tuple(v for pair in reversed(pw) for v in pair)
    return torch.nn.functional.pad(x, flat)

kernel_name = 'interleave_layers__sliding_block_cached__mixer_channel_mlp__decode'

def setup_inputs():

    _w = (lambda a: (lambda t: t.to(torch.bfloat16) if t.is_floating_point() else t)(torch.as_tensor(a)))
    def _A_setup():
        B, Sq, D = 4, 1, 512
        Hq, Hkv, Sk, Dh = 32, 8, 8192, 128
        assert Hq % Hkv == 0, (Hq, Hkv)
        return {
            "x": _w((lambda *s: torch.randn(*s, dtype=torch.bfloat16) * 0.05)(B, Sq, D)),
            "k_cache": _w((lambda *s: torch.randn(*s, dtype=torch.bfloat16) * 1.6)(B, Hkv, Sk, Dh)),
            "v_cache": _w((lambda *s: torch.randn(*s, dtype=torch.bfloat16) * 1.6)(B, Hkv, Sk, Dh)),
            "wq": _w((lambda *s: torch.randn(*s, dtype=torch.bfloat16) * 1.6)(D, Hq * Dh) * (D ** -0.5)),
            "wo": _w((lambda *s: torch.randn(*s, dtype=torch.bfloat16) * 1.6)(Hq * Dh, D) * ((Hq * Dh) ** -0.5)),
        }
    _A_in = _A_setup()

    def _B_setup():
        B, S, D, F = 4, 1, 512, 1792
        return {
            "x": _w((lambda *s: torch.randn(*s, dtype=torch.bfloat16) * 0.05)(B, S, D)),
            "w1": _w((lambda *s: torch.randn(*s, dtype=torch.bfloat16) * 3.2)(D, F) * (D ** -0.5)),
            "b1": _w((lambda *s: torch.randn(*s, dtype=torch.bfloat16) * 1.6)(F)),
            "w2": _w((lambda *s: torch.randn(*s, dtype=torch.bfloat16) * 0.2)(F, D) * (F ** -0.5)),
            "b2": _w((lambda *s: torch.randn(*s, dtype=torch.bfloat16) * 0.2)(D)),
        }
    _B_in = _B_setup()

    return {
        "A_x": _A_in["x"],
        "A_k_cache": _A_in["k_cache"],
        "A_v_cache": _A_in["v_cache"],
        "A_wq": _A_in["wq"],
        "A_wo": _A_in["wo"],
        "B_x": _B_in["x"],
        "B_w1": _B_in["w1"],
        "B_b1": _B_in["b1"],
        "B_w2": _B_in["w2"],
        "B_b2": _B_in["b2"],
    }

def reference(A_x, A_k_cache, A_v_cache, A_wq, A_wo, B_x, B_w1, B_b1, B_w2, B_b2):
    def _A_ref(x, k_cache, v_cache, wq, wo):
        B, Sq, D = x.shape
        Hq, Dh = 32, 128
        Hkv, Sk = k_cache.shape[1], k_cache.shape[2]
        W = min(4096, max(256, Sk // 4))
        rep = Hq // Hkv
        q = (lambda x, *d: x.permute(*d))((x @ wq).reshape(B, Sq, Hq, Dh), 0, 2, 1, 3)
        k = (lambda x, n, axis: torch.repeat_interleave(x, n, dim=axis))(k_cache[:, :, Sk - W:, :], rep, axis=1)
        v = (lambda x, n, axis: torch.repeat_interleave(x, n, dim=axis))(v_cache[:, :, Sk - W:, :], rep, axis=1)
        scores = torch.einsum("bhqd,bhkd->bhqk", q, k) * (Dh ** -0.5)
        p = _softmax(scores, axis=-1)
        o = torch.einsum("bhqk,bhkd->bhqd", p, v)
        return (lambda x, *d: x.permute(*d))(o, 0, 2, 1, 3).reshape(B, Sq, Hq * Dh) @ wo

    def _B_ref(x, w1, b1, w2, b2):
        y = _layernorm(x, axis=-1)
        h = _gelu(torch.einsum("bsd,df->bsf", y, w1) + b1)
        return torch.einsum("bsf,fd->bsd", h, w2) + b2

    x = A_x
    x = x + _A_ref(_layernorm(x, axis=-1), A_k_cache, A_v_cache, A_wq, A_wo)
    x = x + _B_ref(_layernorm(x, axis=-1), B_w1, B_b1, B_w2, B_b2)
    x = x + _A_ref(_layernorm(x, axis=-1), A_k_cache, A_v_cache, A_wq, A_wo)
    x = x + _B_ref(_layernorm(x, axis=-1), B_w1, B_b1, B_w2, B_b2)
    return x
```

```asm
; @launch grid=(256,1,1) block=(512,1,1) lds=94720
.amdgcn_target "amdgcn-amd-amdhsa--gfx950"
.text
.globl interleave_layers__sliding_block_cached__mixer_channel_mlp__decode_kernel
.p2align 8
.type interleave_layers__sliding_block_cached__mixer_channel_mlp__decode_kernel,@function
interleave_layers__sliding_block_cached__mixer_channel_mlp__decode_kernel:
    s_cmp_ge_u32 s2, 256
    s_cbranch_scc1 L_END
    s_getpc_b64 s[94:95]
L_PCREF:
    s_sub_u32 s94, s94, L_PCREF-interleave_layers__sliding_block_cached__mixer_channel_mlp__decode_kernel
    s_subb_u32 s95, s95, 0
    v_lshlrev_b32 v209, 7, v0
    v_cmp_gt_u32 vcc, 128, v0
    s_and_saveexec_b64 s[90:91], vcc
    s_cbranch_execz L_NOCPF
    global_load_dword v168, v209, s[94:95]
L_NOCPF:
    s_mov_b64 exec, -1
    s_load_dwordx2 s[16:17], s[0:1], 24
    s_load_dwordx2 s[8:9], s[0:1], 8
    s_load_dwordx2 s[12:13], s[0:1], 16
    s_load_dwordx2 s[48:49], s[0:1], 96
    s_load_dwordx2 s[4:5], s[0:1], 0
    s_load_dwordx2 s[20:21], s[0:1], 32
    s_load_dwordx2 s[24:25], s[0:1], 48
    s_load_dwordx2 s[28:29], s[0:1], 56
    s_load_dwordx2 s[32:33], s[0:1], 64
    s_load_dwordx2 s[36:37], s[0:1], 72
    s_load_dwordx2 s[40:41], s[0:1], 80
    s_load_dwordx2 s[44:45], s[0:1], 88
    s_mov_b32 s18, 0x400000
    s_mov_b32 s19, 0x00020000
    s_mov_b32 s6, 0x1000
    s_mov_b32 s7, 0x00020000
    s_mov_b32 s46, 0x100
    s_mov_b32 s47, 0x00020000
    v_lshrrev_b32 v200, 6, v0
    v_and_b32 v1, 63, v0
    v_readfirstlane_b32 s52, v200
    s_and_b32 s53, s2, 7
    s_lshr_b32 s54, s2, 3
    s_lshr_b32 s55, s54, 3
    s_and_b32 s56, s54, 7
    s_and_b32 s77, s54, 3
    s_and_b32 s79, s54, 1
    s_and_b32 s78, s52, 3
    v_lshlrev_b32 v232, 4, v1
    v_mov_b32 v237, 0
    v_lshrrev_b32 v208, 3, v1
    v_and_b32 v207, 7, v1
    v_lshlrev_b32 v207, 4, v207
    v_lshl_add_u32 v207, v208, 13, v207
    s_lshl_b32 s67, s53, 10
    s_lshr_b32 s64, s54, 2
    s_lshl_b32 s64, s64, 7
    s_add_u32 s67, s67, s64
    s_lshl_b32 s64, s77, 20
    s_add_u32 s67, s67, s64
    s_lshl_b32 s64, s52, 17
    s_add_u32 s67, s67, s64
    s_lshl_b32 s64, s52, 11
    s_add_u32 s64, s64, 0
    s_mov_b32 m0, s64
    v_mov_b32 v211, 53248
    v_mov_b32 v212, 0
    ds_write_b32 v211, v212
    ds_write_b32 v211, v212 offset:4
    s_waitcnt lgkmcnt(0)
    s_cmp_lg_u32 s52, 7
    s_cbranch_scc1 L_SETUP3
    s_cmp_lg_u32 s2, 0
    s_cbranch_scc1 L_SETUP3
    s_memrealtime s[90:91]
    s_waitcnt lgkmcnt(0)
    s_lshl_b32 s62, s90, 4
    s_or_b32 s62, s62, 0x80000000
    v_mov_b32 v188, s62
    v_mov_b32 v189, 0
    s_mov_b64 exec, 1
    buffer_store_dword v188, v189, s[44:47], 0 offen sc1
    s_mov_b64 exec, -1
L_SETUP3:
    buffer_load_dwordx4 v207, s[16:19], s67 offen nt lds
    s_add_u32 s64, s64, 1024
    s_mov_b32 m0, s64
    s_add_u32 s67, s67, 65536
    buffer_load_dwordx4 v207, s[16:19], s67 offen nt lds
    s_cmp_lg_u32 s52, 5
    s_cbranch_scc1 L_NOX5
    v_mov_b32 v132, 0x3f803f80
    v_mov_b32 v133, 0x3f803f80
    v_mov_b32 v134, 0x3f803f80
    v_mov_b32 v135, 0x3f803f80
    v_mov_b32 v136, 0x3f803f80
    v_mov_b32 v137, 0x3f803f80
    v_mov_b32 v138, 0x3f803f80
    v_mov_b32 v139, 0x3f803f80
    v_mov_b32 v140, 0x3f803f80
    v_mov_b32 v141, 0x3f803f80
    v_mov_b32 v142, 0x3f803f80
    v_mov_b32 v143, 0x3f803f80
    v_mov_b32 v144, 0x3f803f80
    v_mov_b32 v145, 0x3f803f80
    v_mov_b32 v146, 0x3f803f80
    v_mov_b32 v147, 0x3f803f80
    v_and_b32 v209, 3, v1
    v_lshlrev_b32 v209, 10, v209
    v_lshrrev_b32 v210, 4, v1
    v_lshl_add_u32 v209, v210, 4, v209
    s_lshl_b32 s64, s77, 8
    s_mov_b32 exec_lo, 0xf000f
    s_mov_b32 exec_hi, 0xf000f
    buffer_load_dwordx4 v[132:135], v209, s[4:7], s64 offen offset:0
    buffer_load_dwordx4 v[136:139], v209, s[4:7], s64 offen offset:64
    buffer_load_dwordx4 v[140:143], v209, s[4:7], s64 offen offset:128
    buffer_load_dwordx4 v[144:147], v209, s[4:7], s64 offen offset:192
    s_mov_b64 exec, -1
    v_lshlrev_b32 v209, 10, v210
    v_and_b32 v210, 15, v1
    v_lshl_add_u32 v209, v210, 4, v209
    buffer_load_dwordx4 v[148:151], v209, s[4:7], 0 offen offset:0
    buffer_load_dwordx4 v[152:155], v209, s[4:7], 0 offen offset:256
    buffer_load_dwordx4 v[156:159], v209, s[4:7], 0 offen offset:512
    buffer_load_dwordx4 v[160:163], v209, s[4:7], 0 offen offset:768
L_NOX5:
    s_mov_b32 s10, 0x4000000
    s_mov_b32 s11, 0x00020000
    s_mov_b32 s50, 0x10000000
    s_mov_b32 s51, 0x00020000
    s_mov_b32 s14, 0x4000000
    s_mov_b32 s15, 0x00020000
    s_mov_b32 s22, 0x400000
    s_mov_b32 s23, 0x00020000
    s_mov_b32 s26, 0x1c0000
    s_mov_b32 s27, 0x00020000
    s_mov_b32 s30, 0xe00
    s_mov_b32 s31, 0x00020000
    s_mov_b32 s34, 0x1c0000
    s_mov_b32 s35, 0x00020000
    s_mov_b32 s38, 0x400
    s_mov_b32 s39, 0x00020000
    s_mov_b32 s42, 0x1000
    s_mov_b32 s43, 0x00020000
    s_add_u32 s68, s52, s2
    s_add_u32 s68, s68, s54
    s_and_b32 s68, s68, 7
    s_lshr_b32 s69, s52, 1
    s_add_u32 s69, s69, s55
    s_and_b32 s69, s69, 1
    s_lshl_b32 s69, s69, 7
    s_lshl_b32 s70, s55, 3
    s_add_u32 s70, s70, s53
    s_lshl_b32 s70, s70, 21
    s_lshl_b32 s67, s56, 16
    s_add_u32 s70, s70, s67
    s_lshl_b32 s67, s52, 13
    s_add_u32 s70, s70, s67
    s_add_u32 s70, s70, 1572864
    v_and_b32 v206, 3, v1
    v_add_u32 v206, s68, v206
    v_bfe_u32 v207, v1, 2, 1
    v_lshrrev_b32 v208, 3, v1
    v_lshlrev_b32 v209, 4, v208
    v_lshl_add_u32 v209, v207, 8, v209
    v_add_u32 v209, s69, v209
    v_add_u32 v210, 0, v206
    v_and_b32 v210, 7, v210
    v_lshl_add_u32 v164, v210, 10, v209
    v_xor_b32 v166, 0x80, v164
    v_add_u32 v210, 4, v206
    v_and_b32 v210, 7, v210
    v_lshl_add_u32 v165, v210, 10, v209
    v_xor_b32 v167, 0x80, v165
    s_barrier
    s_mul_i32 s57, s53, 221184
    s_lshl_b32 s75, s53, 16
    s_add_u32 s75, s75, 1769472
    s_mul_i32 s65, s54, 6912
    s_add_u32 s65, s65, s57
    s_lshl_b32 s64, s52, 10
    s_add_u32 s64, s64, s65
    s_lshl_b32 s65, s54, 10
    s_add_u32 s65, s65, s75
    s_cmp_eq_u32 s52, 7
    s_cselect_b32 s64, s65, s64
    s_cselect_b32 s65, 0, -1
    v_mov_b32 v184, s65
    v_mov_b32 v185, s65
    v_mov_b32 v186, s65
    v_mov_b32 v187, s65
    s_cmp_eq_u32 s52, 6
    s_cselect_b32 exec_hi, 0xffff, -1
    buffer_store_dwordx4 v[184:187], v232, s[48:51], s64 offen sc1
    s_mov_b64 exec, -1
L_NOPF:
    buffer_load_dwordx4 v[4:7], v164, s[8:11], s70 offen offset:0 nt
    buffer_load_dwordx4 v[8:11], v164, s[8:11], s70 offen offset:512 nt
    buffer_load_dwordx4 v[12:15], v166, s[8:11], s70 offen offset:0 nt
    buffer_load_dwordx4 v[16:19], v166, s[8:11], s70 offen offset:512 nt
L_NOK:
    s_mov_b32 s58, s57
    s_mov_b32 s59, 0
    s_mov_b32 s60, 0
    s_mov_b32 s61, 0
    s_mov_b32 s80, 0xf000f
    s_mov_b32 s81, 0xf000f
    s_mov_b32 s82, 0xf000f0
    s_mov_b32 s83, 0xf000f0
    s_mov_b32 s84, 0xf000f00
    s_mov_b32 s85, 0xf000f00
    s_mov_b32 s86, 0xf000f000
    s_mov_b32 s87, 0xf000f000
    s_mov_b32 s88, 0x001f001f
    s_mov_b32 s89, 0x001f001f
    v_and_b32 v201, 15, v1
    v_lshrrev_b32 v202, 4, v1
    v_and_b32 v203, 3, v1
    v_bfe_u32 v204, v1, 2, 2
    s_getreg_b32 s74, hwreg(HW_REG_XCC_ID)
    s_and_b32 s74, s74, 15
    v_lshl_add_u32 v254, v202, 3, v204
    s_mov_b64 vcc, -1
    s_cmp_eq_u32 s52, 5
    s_cbranch_scc1 L_Q1
    s_branch L_V
L_FREE:
    s_mov_b64 vcc, 0
    v_lshlrev_b32 v237, 12, v202
    v_lshl_add_u32 v237, v204, 8, v237
    v_lshl_add_u32 v237, v203, 4, v237
    s_add_u32 s67, s68, 0
    s_and_b32 s67, s67, 7
    s_lshl_b32 s67, s67, 10
    s_add_u32 s67, s67, s70
    buffer_load_dwordx4 v[68:71], v232, s[12:15], s67 offen nt
    s_add_u32 s67, s68, 1
    s_and_b32 s67, s67, 7
    s_lshl_b32 s67, s67, 10
    s_add_u32 s67, s67, s70
    buffer_load_dwordx4 v[72:75], v232, s[12:15], s67 offen nt
    s_add_u32 s67, s68, 2
    s_and_b32 s67, s67, 7
    s_lshl_b32 s67, s67, 10
    s_add_u32 s67, s67, s70
    buffer_load_dwordx4 v[76:79], v232, s[12:15], s67 offen nt
    s_add_u32 s67, s68, 3
    s_and_b32 s67, s67, 7
    s_lshl_b32 s67, s67, 10
    s_add_u32 s67, s67, s70
    buffer_load_dwordx4 v[80:83], v232, s[12:15], s67 offen nt
    s_add_u32 s67, s68, 4
    s_and_b32 s67, s67, 7
    s_lshl_b32 s67, s67, 10
    s_add_u32 s67, s67, s70
    buffer_load_dwordx4 v[84:87], v232, s[12:15], s67 offen nt
    s_add_u32 s67, s68, 5
    s_and_b32 s67, s67, 7
    s_lshl_b32 s67, s67, 10
    s_add_u32 s67, s67, s70
    buffer_load_dwordx4 v[88:91], v232, s[12:15], s67 offen nt
    s_add_u32 s67, s68, 6
    s_and_b32 s67, s67, 7
    s_lshl_b32 s67, s67, 10
    s_add_u32 s67, s67, s70
    buffer_load_dwordx4 v[92:95], v232, s[12:15], s67 offen nt
    s_add_u32 s67, s68, 7
    s_and_b32 s67, s67, 7
    s_lshl_b32 s67, s67, 10
    s_add_u32 s67, s67, s70
    buffer_load_dwordx4 v[96:99], v232, s[12:15], s67 offen nt
L_V:
    v_and_b32 v201, 15, v1
    v_lshrrev_b32 v202, 4, v1
    v_and_b32 v203, 3, v1
    v_bfe_u32 v204, v1, 2, 2
    v_lshlrev_b32 v237, 12, v202
    v_lshl_add_u32 v237, v204, 8, v237
    v_lshl_add_u32 v237, v203, 4, v237
    s_lshl_b32 s92, s2, 3
    s_add_u32 s92, s92, s52
    s_lshl_b32 s92, s92, 8
    s_add_u32 s92, s92, 4194304
    s_mov_b32 s71, 0x3e0293ee
    s_mov_b32 s72, 0x05040100
    s_mov_b32 s73, 0x07060302
    v_lshlrev_b32 v3, 2, v1
    v_mov_b32 v180, 0x3f803f80
    v_mov_b32 v181, 0x3f803f80
    v_mov_b32 v182, 0x3f803f80
    v_mov_b32 v183, 0x3f803f80
    v_mov_b32 v132, 0x3f803f80
    v_mov_b32 v133, 0x3f803f80
    v_mov_b32 v134, 0x3f803f80
    v_mov_b32 v135, 0x3f803f80
    v_mov_b32 v136, 0x3f803f80
    v_mov_b32 v137, 0x3f803f80
    v_mov_b32 v138, 0x3f803f80
    v_mov_b32 v139, 0x3f803f80
    v_mov_b32 v140, 0x3f803f80
    v_mov_b32 v141, 0x3f803f80
    v_mov_b32 v142, 0x3f803f80
    v_mov_b32 v143, 0x3f803f80
    v_mov_b32 v144, 0x3f803f80
    v_mov_b32 v145, 0x3f803f80
    v_mov_b32 v146, 0x3f803f80
    v_mov_b32 v147, 0x3f803f80
    v_lshlrev_b32 v217, 6, v202
    v_lshl_add_u32 v217, v203, 4, v217
    s_lshl_b32 s67, s77, 10
    v_add_u32 v217, s67, v217
    v_mul_u32_u24 v207, 272, v203
    v_lshl_add_u32 v216, v202, 5, v207
    v_add_u32 v216, 58432, v216
    v_lshl_add_u32 v231, v202, 4, v207
    v_add_u32 v231, 57344, v231
    s_lshl_b32 s67, s52, 13
    s_lshl_b32 s64, s54, 8
    s_add_u32 s67, s67, s64
    s_add_u32 s67, s67, 32768
    v_add_u32 v218, s67, v3
    s_cmp_lg_u32 s52, 4
    s_cbranch_scc1 L_A1
    s_lshl_b32 s67, s54, 3
    s_add_u32 s67, s67, 8192
    v_lshlrev_b32 v218, 8, v203
    v_add_u32 v218, s67, v218
L_A1:
    s_and_b32 s67, s52, 1
    s_lshl_b32 s67, s67, 4
    s_lshr_b32 s64, s52, 1
    s_lshl_b32 s64, s64, 2
    s_add_u32 s67, s67, s64
    v_add_u32 v207, s67, v202
    v_mul_u32_u24 v219, 272, v207
    v_lshl_add_u32 v219, v201, 4, v219
    v_add_u32 v219, 86016, v219
    v_mul_u32_u24 v220, 272, v201
    v_lshl_add_u32 v220, v202, 4, v220
    v_add_u32 v220, 86016, v220
    v_lshlrev_b32 v221, 6, v204
    v_lshl_add_u32 v221, v203, 3, v221
    v_add_u32 v221, 59776, v221
    s_lshl_b32 s67, s55, 12
    s_lshl_b32 s64, s56, 9
    s_add_u32 s67, s67, s64
    s_lshl_b32 s64, s78, 7
    s_add_u32 s67, s67, s64
    s_add_u32 s67, s67, 65536
    v_lshrrev_b32 v207, 5, v1
    v_lshlrev_b32 v222, 5, v204
    v_lshl_add_u32 v222, v207, 4, v222
    v_add_u32 v222, s67, v222
    s_lshl_b32 s76, s77, 3
    s_add_u32 s76, s76, s52
    v_bfe_u32 v208, v1, 3, 1
    s_mov_b32 s64, 221184
    v_and_b32 v209, 7, v1
    v_lshlrev_b32 v209, 4, v209
    s_lshl_b32 s67, s76, 7
    v_add_u32 v209, s67, v209
    v_mul_lo_u32 v223, s64, v208
    v_lshl_add_u32 v223, v202, 12, v223
    v_add_u32 v223, v223, v209
    v_mul_lo_u32 v224, s64, v202
    v_lshl_add_u32 v224, v208, 12, v224
    v_add_u32 v224, v224, v209
    v_bfe_u32 v209, v1, 1, 2
    v_and_b32 v208, 1, v1
    v_bfe_u32 v210, v1, 4, 1
    v_lshlrev_b32 v225, 10, v209
    v_lshl_add_u32 v225, v208, 4, v225
    v_lshl_add_u32 v225, v210, 3, v225
    s_lshl_b32 s67, s76, 5
    v_add_u32 v225, s67, v225
    v_lshlrev_b32 v226, 6, v208
    v_lshl_add_u32 v226, v209, 4, v226
    v_lshl_add_u32 v226, v210, 3, v226
    s_lshl_b32 s67, s76, 7
    v_add_u32 v226, s67, v226
    s_lshr_b32 s66, s54, 2
    s_cmp_ge_u32 s52, 4
    s_cbranch_scc1 L_A3
    s_mul_i32 s67, s77, 10240
    s_lshl_b32 s64, s66, 8
    s_add_u32 s67, s67, s64
    s_lshl_b32 s64, s52, 6
    s_add_u32 s67, s67, s64
    v_lshlrev_b32 v227, 11, v201
    v_lshl_add_u32 v227, v202, 4, v227
    v_add_u32 v227, s67, v227
    s_mul_i32 s67, s79, 384
    s_lshl_b32 s64, s52, 10
    s_add_u32 s67, s67, s64
    v_lshlrev_b32 v228, 3, v1
    v_add_u32 v228, s67, v228
    s_mul_i32 s67, s52, 272
    s_add_u32 s67, s67, 57344
    v_add_u32 v229, s67, v3
    s_mov_b32 s65, s52
    s_branch L_A4
L_A3:
    s_mul_i32 s67, s77, 5120
    s_lshl_b32 s64, s66, 7
    s_add_u32 s67, s67, s64
    s_and_b32 s64, s52, 1
    s_lshl_b32 s64, s64, 6
    s_add_u32 s67, s67, s64
    s_add_u32 s67, s67, 12288
    v_lshlrev_b32 v227, 10, v201
    v_lshl_add_u32 v227, v202, 4, v227
    v_add_u32 v227, s67, v227
    s_cmp_lt_u32 s52, 6
    s_cbranch_scc1 L_A3b
    s_lshl_b32 s67, s79, 12
    s_lshr_b32 s64, s54, 1
    s_lshl_b32 s64, s64, 8
    s_add_u32 s67, s67, s64
    s_and_b32 s64, s52, 1
    s_lshl_b32 s64, s64, 7
    s_add_u32 s67, s67, s64
    s_add_u32 s67, s67, 81920
    v_lshlrev_b32 v227, 5, v203
    v_lshl_add_u32 v227, v207, 4, v227
    v_add_u32 v227, s67, v227
L_A3b:
    s_lshl_b32 s67, s55, 11
    s_lshl_b32 s64, s78, 9
    s_add_u32 s67, s67, s64
    v_lshlrev_b32 v228, 3, v1
    v_add_u32 v228, s67, v228
    s_mul_i32 s67, s78, 272
    s_add_u32 s67, s67, 58432
    v_add_u32 v229, s67, v3
    s_mov_b32 s65, s55
L_A4:
    s_lshl_b32 s67, s65, 4
    v_lshlrev_b32 v230, 6, v1
    v_add_u32 v230, s67, v230
    s_mul_i32 s67, s52, 2560
    s_add_u32 s67, s67, 65536
    v_mul_u32_u24 v233, 272, v202
    v_lshl_add_u32 v233, v201, 4, v233
    v_add_u32 v233, s67, v233
    v_mul_u32_u24 v234, 1088, v207
    v_bfe_u32 v209, v1, 3, 2
    v_mul_u32_u24 v209, 272, v209
    v_add_u32 v234, v234, v209
    v_bfe_u32 v209, v1, 1, 2
    v_lshl_add_u32 v234, v209, 6, v234
    v_lshl_add_u32 v234, v208, 3, v234
    s_lshl_b32 s67, s78, 4
    s_add_u32 s67, s67, 65536
    v_add_u32 v234, s67, v234
    v_lshlrev_b32 v235, 5, v203
    v_add_u32 v235, 59520, v235
    s_lshl_b32 s67, s52, 2
    v_add_u32 v236, s67, v235
    s_cmp_ge_u32 s52, 4
    s_cbranch_scc1 L_A5
    s_lshl_b32 s67, s52, 5
    s_add_u32 s67, s67, 59520
    v_mov_b32 v235, s67
L_A5:
    s_cbranch_vccz L_NOKT
    v_mov_b32 v211, 53248
    v_mov_b32 v212, 1
    v_mov_b32 v213, 0x100
    s_mov_b64 exec, 1
    s_waitcnt vmcnt(5)
    ds_add_u32 v211, v212
    s_waitcnt vmcnt(4)
    ds_add_u32 v211, v213
    s_mov_b64 exec, -1
    s_waitcnt vmcnt(3)
    buffer_load_dwordx4 v[20:23], v165, s[8:11], s70 offen offset:0 nt
    s_waitcnt vmcnt(3)
    buffer_load_dwordx4 v[24:27], v165, s[8:11], s70 offen offset:512 nt
    s_waitcnt vmcnt(3)
    buffer_load_dwordx4 v[28:31], v167, s[8:11], s70 offen offset:0 nt
    s_waitcnt vmcnt(3)
    buffer_load_dwordx4 v[32:35], v167, s[8:11], s70 offen offset:512 nt
L_NOKT:
    s_cbranch_vccz VS_1
    s_waitcnt vmcnt(4)
    s_add_u32 s67, s68, 0
    s_and_b32 s67, s67, 7
    s_lshl_b32 s67, s67, 10
    s_add_u32 s67, s67, s70
    buffer_load_dwordx4 v[68:71], v232, s[12:15], s67 offen nt
VS_1:
    s_cbranch_vccz VS_2
    s_waitcnt vmcnt(4)
    s_add_u32 s67, s68, 1
    s_and_b32 s67, s67, 7
    s_lshl_b32 s67, s67, 10
    s_add_u32 s67, s67, s70
    buffer_load_dwordx4 v[72:75], v232, s[12:15], s67 offen nt
VS_2:
    s_cbranch_vccz VS_3
    s_waitcnt vmcnt(4)
    s_add_u32 s67, s68, 2
    s_and_b32 s67, s67, 7
    s_lshl_b32 s67, s67, 10
    s_add_u32 s67, s67, s70
    buffer_load_dwordx4 v[76:79], v232, s[12:15], s67 offen nt
VS_3:
    s_cbranch_vccz VS_4
    s_waitcnt vmcnt(4)
    s_add_u32 s67, s68, 3
    s_and_b32 s67, s67, 7
    s_lshl_b32 s67, s67, 10
    s_add_u32 s67, s67, s70
    buffer_load_dwordx4 v[80:83], v232, s[12:15], s67 offen nt
VS_4:
    s_cbranch_vccz VS_5
    s_waitcnt vmcnt(4)
    s_add_u32 s67, s68, 4
    s_and_b32 s67, s67, 7
    s_lshl_b32 s67, s67, 10
    s_add_u32 s67, s67, s70
    buffer_load_dwordx4 v[84:87], v232, s[12:15], s67 offen nt
VS_5:
    s_cbranch_vccz VS_6
    s_waitcnt vmcnt(4)
    s_add_u32 s67, s68, 5
    s_and_b32 s67, s67, 7
    s_lshl_b32 s67, s67, 10
    s_add_u32 s67, s67, s70
    buffer_load_dwordx4 v[88:91], v232, s[12:15], s67 offen nt
VS_6:
    s_cbranch_vccz VS_7
    s_waitcnt vmcnt(4)
    s_add_u32 s67, s68, 6
    s_and_b32 s67, s67, 7
    s_lshl_b32 s67, s67, 10
    s_add_u32 s67, s67, s70
    buffer_load_dwordx4 v[92:95], v232, s[12:15], s67 offen nt
VS_7:
    s_cbranch_vccz VS_8
    s_waitcnt vmcnt(4)
    s_add_u32 s67, s68, 7
    s_and_b32 s67, s67, 7
    s_lshl_b32 s67, s67, 10
    s_add_u32 s67, s67, s70
    buffer_load_dwordx4 v[96:99], v232, s[12:15], s67 offen nt
VS_8:
L_VDONE:
    buffer_load_dwordx2 v[240:241], v225, s[4:7], 0 offen
    v_and_b32 v211, 0x3ff, v225
    buffer_load_dwordx2 v[244:245], v211, s[36:39], 0 offen
    s_cmp_ge_u32 s52, 4
    s_cbranch_scc1 L_WEIGHTS
    s_mul_i32 s65, s53, 448
    s_mul_i32 s66, s79, 192
    s_add_u32 s65, s65, s66
    buffer_load_dword v250, v3, s[28:31], s65 offen
L_WEIGHTS:
    v_lshrrev_b32 v211, 3, v1
    v_lshlrev_b32 v211, 10, v211
    v_and_b32 v212, 7, v1
    v_lshl_add_u32 v211, v212, 4, v211
    s_lshl_b32 s67, s53, 2
    s_add_u32 s67, s67, s55
    s_lshl_b32 s67, s67, 17
    s_lshl_b32 s64, s52, 14
    s_add_u32 s67, s67, s64
    s_lshl_b32 s64, s56, 7
    s_add_u32 s67, s67, s64
    s_lshl_b32 s64, s52, 11
    s_add_u32 s64, s64, 16384
    s_cbranch_vccz TH_9
    s_waitcnt vmcnt(7)
TH_9:
    s_mov_b32 m0, s64
    s_add_u32 s64, s64, 1024
    buffer_load_dwordx4 v211, s[20:23], s67 offen nt lds
    s_add_u32 s67, s67, 8192
    s_cbranch_vccz TH_10
    s_waitcnt vmcnt(7)
TH_10:
    s_mov_b32 m0, s64
    s_add_u32 s64, s64, 1024
    buffer_load_dwordx4 v211, s[20:23], s67 offen nt lds
    s_add_u32 s67, s67, 8192
    v_mov_b32 v164, 0
    v_mov_b32 v165, 0
    v_mov_b32 v166, 0
    v_mov_b32 v167, 0
    v_mov_b32 v168, 0
    v_mov_b32 v169, 0
    v_mov_b32 v170, 0
    v_mov_b32 v171, 0
    v_mov_b32 v172, 0
    v_mov_b32 v173, 0
    v_mov_b32 v174, 0
    v_mov_b32 v175, 0
    v_mov_b32 v176, 0
    v_mov_b32 v177, 0
    v_mov_b32 v178, 0
    v_mov_b32 v179, 0
    s_cbranch_vccz L_NOFIX
    s_waitcnt vmcnt(10)
    v_mov_b32 v184, v4
    v_mov_b32 v185, v5
    v_mov_b32 v186, v6
    v_mov_b32 v187, v7
    v_mov_b32_dpp v4, v8 row_ror:8 row_mask:0xf bank_mask:0xc
    v_mov_b32_dpp v5, v9 row_ror:8 row_mask:0xf bank_mask:0xc
    v_mov_b32_dpp v6, v10 row_ror:8 row_mask:0xf bank_mask:0xc
    v_mov_b32_dpp v7, v11 row_ror:8 row_mask:0xf bank_mask:0xc
    v_mov_b32_dpp v8, v184 row_ror:8 row_mask:0xf bank_mask:0x3
    v_mov_b32_dpp v9, v185 row_ror:8 row_mask:0xf bank_mask:0x3
    v_mov_b32_dpp v10, v186 row_ror:8 row_mask:0xf bank_mask:0x3
    v_mov_b32_dpp v11, v187 row_ror:8 row_mask:0xf bank_mask:0x3
    v_mov_b32 v184, v12
    v_mov_b32 v185, v13
    v_mov_b32 v186, v14
    v_mov_b32 v187, v15
    v_mov_b32_dpp v12, v16 row_ror:8 row_mask:0xf bank_mask:0xc
    v_mov_b32_dpp v13, v17 row_ror:8 row_mask:0xf bank_mask:0xc
    v_mov_b32_dpp v14, v18 row_ror:8 row_mask:0xf bank_mask:0xc
    v_mov_b32_dpp v15, v19 row_ror:8 row_mask:0xf bank_mask:0xc
    v_mov_b32_dpp v16, v184 row_ror:8 row_mask:0xf bank_mask:0x3
    v_mov_b32_dpp v17, v185 row_ror:8 row_mask:0xf bank_mask:0x3
    v_mov_b32_dpp v18, v186 row_ror:8 row_mask:0xf bank_mask:0x3
    v_mov_b32_dpp v19, v187 row_ror:8 row_mask:0xf bank_mask:0x3
    v_mov_b32 v184, v20
    v_mov_b32 v185, v21
    v_mov_b32 v186, v22
    v_mov_b32 v187, v23
    v_mov_b32_dpp v20, v24 row_ror:8 row_mask:0xf bank_mask:0xc
    v_mov_b32_dpp v21, v25 row_ror:8 row_mask:0xf bank_mask:0xc
    v_mov_b32_dpp v22, v26 row_ror:8 row_mask:0xf bank_mask:0xc
    v_mov_b32_dpp v23, v27 row_ror:8 row_mask:0xf bank_mask:0xc
    v_mov_b32_dpp v24, v184 row_ror:8 row_mask:0xf bank_mask:0x3
    v_mov_b32_dpp v25, v185 row_ror:8 row_mask:0xf bank_mask:0x3
    v_mov_b32_dpp v26, v186 row_ror:8 row_mask:0xf bank_mask:0x3
    v_mov_b32_dpp v27, v187 row_ror:8 row_mask:0xf bank_mask:0x3
    v_mov_b32 v184, v28
    v_mov_b32 v185, v29
    v_mov_b32 v186, v30
    v_mov_b32 v187, v31
    v_mov_b32_dpp v28, v32 row_ror:8 row_mask:0xf bank_mask:0xc
    v_mov_b32_dpp v29, v33 row_ror:8 row_mask:0xf bank_mask:0xc
    v_mov_b32_dpp v30, v34 row_ror:8 row_mask:0xf bank_mask:0xc
    v_mov_b32_dpp v31, v35 row_ror:8 row_mask:0xf bank_mask:0xc
    v_mov_b32_dpp v32, v184 row_ror:8 row_mask:0xf bank_mask:0x3
    v_mov_b32_dpp v33, v185 row_ror:8 row_mask:0xf bank_mask:0x3
    v_mov_b32_dpp v34, v186 row_ror:8 row_mask:0xf bank_mask:0x3
    v_mov_b32_dpp v35, v187 row_ror:8 row_mask:0xf bank_mask:0x3
L_NOFIX:
    v_lshrrev_b32 v211, 2, v1
    v_and_b32 v212, 3, v1
    v_lshlrev_b32 v212, 4, v212
    v_mul_u32_u24 v213, 3584, v211
    v_add_u32 v213, v213, v212
    s_lshl_b32 s67, s77, 3
    s_add_u32 s67, s67, s52
    s_mul_i32 s67, s67, 57344
    s_mul_i32 s65, s53, 448
    s_add_u32 s67, s67, s65
    s_lshr_b32 s64, s54, 2
    s_min_u32 s64, s64, 6
    s_lshl_b32 s64, s64, 6
    s_add_u32 s67, s67, s64
    s_lshl_b32 s64, s52, 10
    s_add_u32 s66, s64, 32768
    s_mov_b32 m0, s66
    s_cbranch_vccz TH_11
    s_waitcnt vmcnt(7)
TH_11:
    buffer_load_dwordx4 v213, s[24:27], s67 offen nt lds
    s_cmp_lg_u32 s52, 5
    s_cbranch_scc1 L_QBAR0
    s_branch L_QT0
L_Q1:
    v_mov_b32 v205, 0x3f803f80
    v_mov_b32 v207, 0
    v_mov_b32 v208, 0
    v_mov_b32 v214, 0
    v_lshlrev_b32 v212, 7, v254
    v_lshl_add_u32 v212, v203, 3, v212
    buffer_load_dword v180, v214, s[44:47], 0 offen sc1
    s_waitcnt vmcnt(6)
    buffer_load_dword v181, v214, s[44:47], 0 offen sc1
    buffer_load_dwordx4 v[20:23], v165, s[8:11], s70 offen offset:0 nt
    buffer_load_dwordx4 v[24:27], v165, s[8:11], s70 offen offset:512 nt
    buffer_load_dwordx4 v[28:31], v167, s[8:11], s70 offen offset:0 nt
    buffer_load_dwordx4 v[32:35], v167, s[8:11], s70 offen offset:512 nt
    v_dot2c_f32_bf16 v207, v148, v148
    v_dot2c_f32_bf16 v208, v148, v205
    v_dot2c_f32_bf16 v207, v149, v149
    v_dot2c_f32_bf16 v208, v149, v205
    v_dot2c_f32_bf16 v207, v150, v150
    v_dot2c_f32_bf16 v208, v150, v205
    v_dot2c_f32_bf16 v207, v151, v151
    v_dot2c_f32_bf16 v208, v151, v205
    v_dot2c_f32_bf16 v207, v152, v152
    v_dot2c_f32_bf16 v208, v152, v205
    v_dot2c_f32_bf16 v207, v153, v153
    v_dot2c_f32_bf16 v208, v153, v205
    v_dot2c_f32_bf16 v207, v154, v154
    v_dot2c_f32_bf16 v208, v154, v205
    v_dot2c_f32_bf16 v207, v155, v155
    v_dot2c_f32_bf16 v208, v155, v205
    v_dot2c_f32_bf16 v207, v156, v156
    v_dot2c_f32_bf16 v208, v156, v205
    v_dot2c_f32_bf16 v207, v157, v157
    v_dot2c_f32_bf16 v208, v157, v205
    v_dot2c_f32_bf16 v207, v158, v158
    v_dot2c_f32_bf16 v208, v158, v205
    v_dot2c_f32_bf16 v207, v159, v159
    v_dot2c_f32_bf16 v208, v159, v205
    v_dot2c_f32_bf16 v207, v160, v160
    v_dot2c_f32_bf16 v208, v160, v205
    v_dot2c_f32_bf16 v207, v161, v161
    v_dot2c_f32_bf16 v208, v161, v205
    v_dot2c_f32_bf16 v207, v162, v162
    v_dot2c_f32_bf16 v208, v162, v205
    v_dot2c_f32_bf16 v207, v163, v163
    v_dot2c_f32_bf16 v208, v163, v205
    v_mov_b32 v211, 53248
    s_mov_b32 s63, 0
L_WQW:
    ds_read_b32 v213, v211
    s_add_u32 s63, s63, 1
    s_waitcnt lgkmcnt(0)
    v_readfirstlane_b32 s67, v213
    s_cmp_ge_u32 s63, 131072
    s_cbranch_scc1 L_WQD
    s_and_b32 s67, s67, 0xff
    s_cmp_lt_u32 s67, 7
    s_cbranch_scc1 L_WQW
L_WQD:
    ds_read_b64_tr_b16 v[36:37], v212 offset:0
    ds_read_b64_tr_b16 v[38:39], v212 offset:512
    ds_read_b64_tr_b16 v[40:41], v212 offset:4096
    ds_read_b64_tr_b16 v[42:43], v212 offset:4608
    ds_read_b64_tr_b16 v[44:45], v212 offset:8192
    ds_read_b64_tr_b16 v[46:47], v212 offset:8704
    ds_read_b64_tr_b16 v[48:49], v212 offset:12288
    ds_read_b64_tr_b16 v[50:51], v212 offset:12800
    s_waitcnt lgkmcnt(0)
    ds_read_b64_tr_b16 v[52:53], v212 offset:32
    ds_read_b64_tr_b16 v[54:55], v212 offset:544
    ds_read_b64_tr_b16 v[56:57], v212 offset:4128
    ds_read_b64_tr_b16 v[58:59], v212 offset:4640
    ds_read_b64_tr_b16 v[60:61], v212 offset:8224
    ds_read_b64_tr_b16 v[62:63], v212 offset:8736
    ds_read_b64_tr_b16 v[64:65], v212 offset:12320
    ds_read_b64_tr_b16 v[66:67], v212 offset:12832
    v_mfma_f32_16x16x32_bf16 v[184:187], v[36:39], v[132:135], 0
    v_mfma_f32_16x16x32_bf16 v[184:187], v[40:43], v[136:139], v[184:187]
    v_mfma_f32_16x16x32_bf16 v[184:187], v[44:47], v[140:143], v[184:187]
    v_mfma_f32_16x16x32_bf16 v[184:187], v[48:51], v[144:147], v[184:187]
    s_waitcnt lgkmcnt(0)
    ds_read_b64_tr_b16 v[100:101], v212 offset:64
    ds_read_b64_tr_b16 v[102:103], v212 offset:576
    ds_read_b64_tr_b16 v[104:105], v212 offset:4160
    ds_read_b64_tr_b16 v[106:107], v212 offset:4672
    ds_read_b64_tr_b16 v[108:109], v212 offset:8256
    ds_read_b64_tr_b16 v[110:111], v212 offset:8768
    ds_read_b64_tr_b16 v[112:113], v212 offset:12352
    ds_read_b64_tr_b16 v[114:115], v212 offset:12864
    v_mfma_f32_16x16x32_bf16 v[188:191], v[52:55], v[132:135], 0
    v_mfma_f32_16x16x32_bf16 v[188:191], v[56:59], v[136:139], v[188:191]
    v_mfma_f32_16x16x32_bf16 v[188:191], v[60:63], v[140:143], v[188:191]
    v_mfma_f32_16x16x32_bf16 v[188:191], v[64:67], v[144:147], v[188:191]
    s_waitcnt lgkmcnt(0)
    ds_read_b64_tr_b16 v[116:117], v212 offset:96
    ds_read_b64_tr_b16 v[118:119], v212 offset:608
    ds_read_b64_tr_b16 v[120:121], v212 offset:4192
    ds_read_b64_tr_b16 v[122:123], v212 offset:4704
    ds_read_b64_tr_b16 v[124:125], v212 offset:8288
    ds_read_b64_tr_b16 v[126:127], v212 offset:8800
    ds_read_b64_tr_b16 v[128:129], v212 offset:12384
    ds_read_b64_tr_b16 v[130:131], v212 offset:12896
    v_mfma_f32_16x16x32_bf16 v[192:195], v[100:103], v[132:135], 0
    v_mfma_f32_16x16x32_bf16 v[192:195], v[104:107], v[136:139], v[192:195]
    v_mfma_f32_16x16x32_bf16 v[192:195], v[108:111], v[140:143], v[192:195]
    v_mfma_f32_16x16x32_bf16 v[192:195], v[112:115], v[144:147], v[192:195]
    s_waitcnt lgkmcnt(0)
    v_mfma_f32_16x16x32_bf16 v[196:199], v[116:119], v[132:135], 0
    v_mfma_f32_16x16x32_bf16 v[196:199], v[120:123], v[136:139], v[196:199]
    v_mfma_f32_16x16x32_bf16 v[196:199], v[124:127], v[140:143], v[196:199]
    v_mfma_f32_16x16x32_bf16 v[196:199], v[128:131], v[144:147], v[196:199]
    v_add_f32_dpp v207, v207, v207 quad_perm:[1,0,3,2] row_mask:0xf bank_mask:0xf
    v_add_f32_dpp v208, v208, v208 quad_perm:[1,0,3,2] row_mask:0xf bank_mask:0xf
    s_nop 0
    v_add_f32_dpp v207, v207, v207 quad_perm:[2,3,0,1] row_mask:0xf bank_mask:0xf
    v_add_f32_dpp v208, v208, v208 quad_perm:[2,3,0,1] row_mask:0xf bank_mask:0xf
    s_nop 0
    v_add_f32_dpp v207, v207, v207 row_half_mirror row_mask:0xf bank_mask:0xf
    v_add_f32_dpp v208, v208, v208 row_half_mirror row_mask:0xf bank_mask:0xf
    s_nop 0
    v_add_f32_dpp v207, v207, v207 row_mirror row_mask:0xf bank_mask:0xf
    v_add_f32_dpp v208, v208, v208 row_mirror row_mask:0xf bank_mask:0xf
    s_nop 0
    v_mul_f32 v208, 0x3b000000, v208
    v_mul_f32 v207, 0x3b000000, v207
    v_fma_f32 v207, -v208, v208, v207
    v_max_f32 v207, 0, v207
    v_add_f32 v209, 0x3727c5ac, v207
    v_rsq_f32 v209, v209
    s_nop 0
    v_mov_b32 v207, v209
    v_sub_f32 v208, 0, v208
    v_mov_b32 v209, v207
    v_lshlrev_b32 v206, 3, v202
    ds_write_b64 v206, v[208:209] offset:49152
    v_lshlrev_b32 v206, 3, v203
    s_waitcnt lgkmcnt(0)
    ds_read_b64 v[208:209], v206 offset:49152
    v_mov_b32_dpp v36, v184 row_shl:4 row_mask:0xf bank_mask:0xf
    v_mov_b32_dpp v37, v185 row_shl:4 row_mask:0xf bank_mask:0xf
    v_mov_b32_dpp v38, v186 row_shl:4 row_mask:0xf bank_mask:0xf
    v_mov_b32_dpp v39, v187 row_shl:4 row_mask:0xf bank_mask:0xf
    v_mov_b32_dpp v40, v188 row_shl:4 row_mask:0xf bank_mask:0xf
    v_mov_b32_dpp v41, v189 row_shl:4 row_mask:0xf bank_mask:0xf
    v_mov_b32_dpp v42, v190 row_shl:4 row_mask:0xf bank_mask:0xf
    v_mov_b32_dpp v43, v191 row_shl:4 row_mask:0xf bank_mask:0xf
    v_mov_b32_dpp v44, v192 row_shl:4 row_mask:0xf bank_mask:0xf
    v_mov_b32_dpp v45, v193 row_shl:4 row_mask:0xf bank_mask:0xf
    v_mov_b32_dpp v46, v194 row_shl:4 row_mask:0xf bank_mask:0xf
    v_mov_b32_dpp v47, v195 row_shl:4 row_mask:0xf bank_mask:0xf
    v_mov_b32_dpp v48, v196 row_shl:4 row_mask:0xf bank_mask:0xf
    v_mov_b32_dpp v49, v197 row_shl:4 row_mask:0xf bank_mask:0xf
    v_mov_b32_dpp v50, v198 row_shl:4 row_mask:0xf bank_mask:0xf
    v_mov_b32_dpp v51, v199 row_shl:4 row_mask:0xf bank_mask:0xf
    s_waitcnt lgkmcnt(0)
    v_fmac_f32 v184, v36, v208
    v_fmac_f32 v185, v37, v208
    v_fmac_f32 v186, v38, v208
    v_fmac_f32 v187, v39, v208
    v_fmac_f32 v188, v40, v208
    v_fmac_f32 v189, v41, v208
    v_fmac_f32 v190, v42, v208
    v_fmac_f32 v191, v43, v208
    v_fmac_f32 v192, v44, v208
    v_fmac_f32 v193, v45, v208
    v_fmac_f32 v194, v46, v208
    v_fmac_f32 v195, v47, v208
    v_fmac_f32 v196, v48, v208
    v_fmac_f32 v197, v49, v208
    v_fmac_f32 v198, v50, v208
    v_fmac_f32 v199, v51, v208
    v_mul_f32 v184, v184, v209
    v_mul_f32 v185, v185, v209
    v_mul_f32 v186, v186, v209
    v_mul_f32 v187, v187, v209
    v_mul_f32 v188, v188, v209
    v_mul_f32 v189, v189, v209
    v_mul_f32 v190, v190, v209
    v_mul_f32 v191, v191, v209
    v_mul_f32 v192, v192, v209
    v_mul_f32 v193, v193, v209
    v_mul_f32 v194, v194, v209
    v_mul_f32 v195, v195, v209
    v_mul_f32 v196, v196, v209
    v_mul_f32 v197, v197, v209
    v_mul_f32 v198, v198, v209
    v_mul_f32 v199, v199, v209
    v_cvt_pk_bf16_f32 v36, v184, v185
    v_cvt_pk_bf16_f32 v38, v186, v187
    v_cvt_pk_bf16_f32 v40, v188, v189
    v_cvt_pk_bf16_f32 v42, v190, v191
    v_cvt_pk_bf16_f32 v44, v192, v193
    v_cvt_pk_bf16_f32 v46, v194, v195
    v_cvt_pk_bf16_f32 v48, v196, v197
    v_cvt_pk_bf16_f32 v50, v198, v199
    v_lshlrev_b32 v206, 6, v203
    v_lshl_add_u32 v206, v202, 4, v206
    s_lshl_b32 s65, s54, 10
    s_add_u32 s65, s65, s75
    s_mov_b32 s63, 0
    s_waitcnt vmcnt(4)
    v_or_b32 v213, v180, v181
L_NONCE:
    s_nop 0
    v_readfirstlane_b32 s62, v213
    s_add_u32 s63, s63, 1
    s_cmp_ge_u32 s63, 131072
    s_cbranch_scc1 L_NONCE_D
    s_cmp_lg_u32 s62, 0
    s_cbranch_scc1 L_NONCE_D
    buffer_load_dword v213, v214, s[44:47], 0 offen sc1
    s_waitcnt vmcnt(0)
    s_branch L_NONCE
L_NONCE_D:
    s_mov_b32 s63, 0
L_ACKW:
    ds_read_b32 v213, v211
    s_add_u32 s63, s63, 1
    s_waitcnt lgkmcnt(0)
    v_readfirstlane_b32 s67, v213
    s_cmp_ge_u32 s63, 131072
    s_cbranch_scc1 L_ACKD
    s_cmp_lt_u32 s67, 0x700
    s_cbranch_scc1 L_ACKW
L_ACKD:
    s_or_b32 s67, s62, s74
    v_mov_b32 v213, s67
    ds_write_b32 v211, v213 offset:4
    v_mov_b32 v37, s67
    v_mov_b32 v39, s67
    v_mov_b32 v41, s67
    v_mov_b32 v43, s67
    v_mov_b32 v45, s67
    v_mov_b32 v47, s67
    v_mov_b32 v49, s67
    v_mov_b32 v51, s67
    s_mov_b64 exec, s[80:81]
    buffer_store_dwordx4 v[36:39], v206, s[48:51], s65 offen offset:0 sc1
    buffer_store_dwordx4 v[40:43], v206, s[48:51], s65 offen offset:256 sc1
    buffer_store_dwordx4 v[44:47], v206, s[48:51], s65 offen offset:512 sc1
    buffer_store_dwordx4 v[48:51], v206, s[48:51], s65 offen offset:768 sc1
    s_mov_b64 exec, -1
    s_branch L_FREE
L_W6:
L_QT0:
    s_mov_b32 s63, 0
    s_or_b32 s67, s62, s74
    v_mov_b32 v158, s67
    s_lshl_b32 s64, s55, 6
    s_add_u32 s64, s64, s75
    s_add_u32 s65, s64, 16384
    buffer_load_dwordx4 v[36:39], v237, s[48:51], s64 offen offset:0 sc1
    buffer_load_dwordx4 v[40:43], v237, s[48:51], s65 offen offset:0 sc1
    buffer_load_dwordx4 v[44:47], v237, s[48:51], s64 offen offset:1024 sc1
    buffer_load_dwordx4 v[48:51], v237, s[48:51], s65 offen offset:1024 sc1
    buffer_load_dwordx4 v[52:55], v237, s[48:51], s64 offen offset:2048 sc1
    buffer_load_dwordx4 v[56:59], v237, s[48:51], s65 offen offset:2048 sc1
    buffer_load_dwordx4 v[60:63], v237, s[48:51], s64 offen offset:3072 sc1
    buffer_load_dwordx4 v[64:67], v237, s[48:51], s65 offen offset:3072 sc1
    s_waitcnt vmcnt(21)
    v_mov_b32 v184, v4
    v_mov_b32 v185, v5
    v_mov_b32 v186, v6
    v_mov_b32 v187, v7
    v_mov_b32_dpp v4, v8 row_ror:8 row_mask:0xf bank_mask:0xc
    v_mov_b32_dpp v5, v9 row_ror:8 row_mask:0xf bank_mask:0xc
    v_mov_b32_dpp v6, v10 row_ror:8 row_mask:0xf bank_mask:0xc
    v_mov_b32_dpp v7, v11 row_ror:8 row_mask:0xf bank_mask:0xc
    v_mov_b32_dpp v8, v184 row_ror:8 row_mask:0xf bank_mask:0x3
    v_mov_b32_dpp v9, v185 row_ror:8 row_mask:0xf bank_mask:0x3
    v_mov_b32_dpp v10, v186 row_ror:8 row_mask:0xf bank_mask:0x3
    v_mov_b32_dpp v11, v187 row_ror:8 row_mask:0xf bank_mask:0x3
    v_mov_b32 v184, v12
    v_mov_b32 v185, v13
    v_mov_b32 v186, v14
    v_mov_b32 v187, v15
    v_mov_b32_dpp v12, v16 row_ror:8 row_mask:0xf bank_mask:0xc
    v_mov_b32_dpp v13, v17 row_ror:8 row_mask:0xf bank_mask:0xc
    v_mov_b32_dpp v14, v18 row_ror:8 row_mask:0xf bank_mask:0xc
    v_mov_b32_dpp v15, v19 row_ror:8 row_mask:0xf bank_mask:0xc
    v_mov_b32_dpp v16, v184 row_ror:8 row_mask:0xf bank_mask:0x3
    v_mov_b32_dpp v17, v185 row_ror:8 row_mask:0xf bank_mask:0x3
    v_mov_b32_dpp v18, v186 row_ror:8 row_mask:0xf bank_mask:0x3
    v_mov_b32_dpp v19, v187 row_ror:8 row_mask:0xf bank_mask:0x3
    v_mov_b32 v184, v20
    v_mov_b32 v185, v21
    v_mov_b32 v186, v22
    v_mov_b32 v187, v23
    v_mov_b32_dpp v20, v24 row_ror:8 row_mask:0xf bank_mask:0xc
    v_mov_b32_dpp v21, v25 row_ror:8 row_mask:0xf bank_mask:0xc
    v_mov_b32_dpp v22, v26 row_ror:8 row_mask:0xf bank_mask:0xc
    v_mov_b32_dpp v23, v27 row_ror:8 row_mask:0xf bank_mask:0xc
    v_mov_b32_dpp v24, v184 row_ror:8 row_mask:0xf bank_mask:0x3
    v_mov_b32_dpp v25, v185 row_ror:8 row_mask:0xf bank_mask:0x3
    v_mov_b32_dpp v26, v186 row_ror:8 row_mask:0xf bank_mask:0x3
    v_mov_b32_dpp v27, v187 row_ror:8 row_mask:0xf bank_mask:0x3
    v_mov_b32 v184, v28
    v_mov_b32 v185, v29
    v_mov_b32 v186, v30
    v_mov_b32 v187, v31
    v_mov_b32_dpp v28, v32 row_ror:8 row_mask:0xf bank_mask:0xc
    v_mov_b32_dpp v29, v33 row_ror:8 row_mask:0xf bank_mask:0xc
    v_mov_b32_dpp v30, v34 row_ror:8 row_mask:0xf bank_mask:0xc
    v_mov_b32_dpp v31, v35 row_ror:8 row_mask:0xf bank_mask:0xc
    v_mov_b32_dpp v32, v184 row_ror:8 row_mask:0xf bank_mask:0x3
    v_mov_b32_dpp v33, v185 row_ror:8 row_mask:0xf bank_mask:0x3
    v_mov_b32_dpp v34, v186 row_ror:8 row_mask:0xf bank_mask:0x3
    v_mov_b32_dpp v35, v187 row_ror:8 row_mask:0xf bank_mask:0x3
    s_waitcnt vmcnt(0)
    s_branch L_QT_CHK
L_QT:
    s_lshl_b32 s64, s55, 6
    s_add_u32 s64, s64, s75
    s_add_u32 s65, s64, 16384
    buffer_load_dwordx4 v[36:39], v237, s[48:51], s64 offen offset:0 sc1
    buffer_load_dwordx4 v[40:43], v237, s[48:51], s65 offen offset:0 sc1
    buffer_load_dwordx4 v[44:47], v237, s[48:51], s64 offen offset:1024 sc1
    buffer_load_dwordx4 v[48:51], v237, s[48:51], s65 offen offset:1024 sc1
    buffer_load_dwordx4 v[52:55], v237, s[48:51], s64 offen offset:2048 sc1
    buffer_load_dwordx4 v[56:59], v237, s[48:51], s65 offen offset:2048 sc1
    buffer_load_dwordx4 v[60:63], v237, s[48:51], s64 offen offset:3072 sc1
    buffer_load_dwordx4 v[64:67], v237, s[48:51], s65 offen offset:3072 sc1
    s_waitcnt vmcnt(0)
L_QT_CHK:
    v_mov_b32 v159, 0
    v_xor_b32 v160, v158, v37
    v_xor_b32 v161, v158, v39
    v_or3_b32 v159, v159, v160, v161
    v_xor_b32 v160, v158, v41
    v_xor_b32 v161, v158, v43
    v_or3_b32 v159, v159, v160, v161
    v_xor_b32 v160, v158, v45
    v_xor_b32 v161, v158, v47
    v_or3_b32 v159, v159, v160, v161
    v_xor_b32 v160, v158, v49
    v_xor_b32 v161, v158, v51
    v_or3_b32 v159, v159, v160, v161
    v_xor_b32 v160, v158, v53
    v_xor_b32 v161, v158, v55
    v_or3_b32 v159, v159, v160, v161
    v_xor_b32 v160, v158, v57
    v_xor_b32 v161, v158, v59
    v_or3_b32 v159, v159, v160, v161
    v_xor_b32 v160, v158, v61
    v_xor_b32 v161, v158, v63
    v_or3_b32 v159, v159, v160, v161
    v_xor_b32 v160, v158, v65
    v_xor_b32 v161, v158, v67
    v_or3_b32 v159, v159, v160, v161
    v_cmp_lt_u32 vcc, 15, v159
    s_add_u32 s63, s63, 1
    s_cmp_ge_u32 s63, 131072
    s_cbranch_scc1 L_QT_DONE
    s_cbranch_vccnz L_QT
L_QT_DONE:
    v_lshlrev_b32 v184, 16, v36
    v_and_b32 v185, 0xffff0000, v36
    v_lshlrev_b32 v186, 16, v44
    v_and_b32 v187, 0xffff0000, v44
    v_pk_add_f32 v[184:185], v[184:185], v[186:187]
    v_lshlrev_b32 v186, 16, v52
    v_and_b32 v187, 0xffff0000, v52
    v_pk_add_f32 v[184:185], v[184:185], v[186:187]
    v_lshlrev_b32 v186, 16, v60
    v_and_b32 v187, 0xffff0000, v60
    v_pk_add_f32 v[184:185], v[184:185], v[186:187]
    v_cvt_pk_bf16_f32 v148, v184, v185
    v_lshlrev_b32 v184, 16, v38
    v_and_b32 v185, 0xffff0000, v38
    v_lshlrev_b32 v186, 16, v46
    v_and_b32 v187, 0xffff0000, v46
    v_pk_add_f32 v[184:185], v[184:185], v[186:187]
    v_lshlrev_b32 v186, 16, v54
    v_and_b32 v187, 0xffff0000, v54
    v_pk_add_f32 v[184:185], v[184:185], v[186:187]
    v_lshlrev_b32 v186, 16, v62
    v_and_b32 v187, 0xffff0000, v62
    v_pk_add_f32 v[184:185], v[184:185], v[186:187]
    v_cvt_pk_bf16_f32 v149, v184, v185
    v_lshlrev_b32 v184, 16, v40
    v_and_b32 v185, 0xffff0000, v40
    v_lshlrev_b32 v186, 16, v48
    v_and_b32 v187, 0xffff0000, v48
    v_pk_add_f32 v[184:185], v[184:185], v[186:187]
    v_lshlrev_b32 v186, 16, v56
    v_and_b32 v187, 0xffff0000, v56
    v_pk_add_f32 v[184:185], v[184:185], v[186:187]
    v_lshlrev_b32 v186, 16, v64
    v_and_b32 v187, 0xffff0000, v64
    v_pk_add_f32 v[184:185], v[184:185], v[186:187]
    v_cvt_pk_bf16_f32 v150, v184, v185
    v_lshlrev_b32 v184, 16, v42
    v_and_b32 v185, 0xffff0000, v42
    v_lshlrev_b32 v186, 16, v50
    v_and_b32 v187, 0xffff0000, v50
    v_pk_add_f32 v[184:185], v[184:185], v[186:187]
    v_lshlrev_b32 v186, 16, v58
    v_and_b32 v187, 0xffff0000, v58
    v_pk_add_f32 v[184:185], v[184:185], v[186:187]
    v_lshlrev_b32 v186, 16, v66
    v_and_b32 v187, 0xffff0000, v66
    v_pk_add_f32 v[184:185], v[184:185], v[186:187]
    v_cvt_pk_bf16_f32 v151, v184, v185
    v_lshrrev_b32 v211, 5, v1
    v_mul_u32_u24 v211, 272, v211
    v_and_b32 v212, 31, v1
    v_lshl_add_u32 v211, v212, 3, v211
    ds_write_b64 v211, v[148:149] offset:58432
    ds_write_b64 v211, v[150:151] offset:58976
    v_cmp_ne_u32 vcc, 0, v159
    s_cmp_eq_u64 vcc, 0
    s_cselect_b32 s61, 1, 0
    v_mov_b32 v212, s61
    v_mov_b32 v213, 58688
    ds_write_b32 v213, v212
    s_cmp_lg_u32 s54, 0
    s_cbranch_scc1 L_NOLEAD
    s_lshl_b32 s67, s53, 2
    v_mov_b32 v212, 1
    v_mov_b32 v213, s67
    s_mov_b64 exec, 1
    buffer_store_dword v212, v213, s[44:47], 0 offen offset:128 sc1
    s_mov_b64 exec, -1
L_NOLEAD:
    s_mul_i32 s64, s54, 6912
    s_add_u32 s64, s64, s57
    v_lshlrev_b32 v212, 7, v1
    s_mov_b32 exec_lo, 0xffffffff
    s_mov_b32 exec_hi, 0x3fffff
    buffer_load_dword v250, v212, s[48:51], s64 offen sc1
    s_mov_b64 exec, -1
    s_waitcnt lgkmcnt(0)
L_QBAR0:
    s_barrier
    v_mov_b32 v213, 58688
    ds_read_b32 v212, v213
    s_waitcnt lgkmcnt(0)
    v_readfirstlane_b32 s61, v212
L_LOOP:
    v_add_u32 v200, s69, v216
    v_subrev_u32 v201, s69, v216
    ds_read_b128 v[148:151], v200
    ds_read_b128 v[152:155], v200 offset:16
    ds_read_b128 v[156:159], v201 offset:128
    ds_read_b128 v[160:163], v201 offset:144
    s_waitcnt lgkmcnt(3)
    v_mfma_f32_16x16x32_bf16 v[184:187], v[4:7], v[148:151], 0
    v_mfma_f32_16x16x32_bf16 v[188:191], v[20:23], v[148:151], 0
    s_waitcnt lgkmcnt(2)
    v_mfma_f32_16x16x32_bf16 v[184:187], v[8:11], v[152:155], v[184:187]
    v_mfma_f32_16x16x32_bf16 v[188:191], v[24:27], v[152:155], v[188:191]
    s_waitcnt lgkmcnt(1)
    v_mfma_f32_16x16x32_bf16 v[184:187], v[12:15], v[156:159], v[184:187]
    v_mfma_f32_16x16x32_bf16 v[188:191], v[28:31], v[156:159], v[188:191]
    s_waitcnt lgkmcnt(0)
    v_mfma_f32_16x16x32_bf16 v[184:187], v[16:19], v[160:163], v[184:187]
    v_mfma_f32_16x16x32_bf16 v[188:191], v[32:35], v[160:163], v[188:191]
    s_nop 7
    v_max3_f32 v200, v184, v185, v186
    v_max3_f32 v201, v187, v188, v189
    v_max3_f32 v200, v200, v190, v191
    v_max_f32 v200, v200, v201
    v_mov_b32 v201, v200
    s_nop 1
    v_permlane16_swap_b32 v200, v201
    s_nop 0
    v_max_f32 v200, v200, v201
    v_mov_b32 v201, v200
    s_nop 1
    v_permlane32_swap_b32 v200, v201
    s_nop 0
    v_max_f32 v200, v200, v201
    v_mul_f32 v2, s71, v200
    ds_write_b32 v236, v2
    v_fma_f32 v184, v184, s71, -v2
    v_fma_f32 v185, v185, s71, -v2
    v_fma_f32 v186, v186, s71, -v2
    v_fma_f32 v187, v187, s71, -v2
    v_fma_f32 v188, v188, s71, -v2
    v_fma_f32 v189, v189, s71, -v2
    v_fma_f32 v190, v190, s71, -v2
    v_fma_f32 v191, v191, s71, -v2
    v_exp_f32 v184, v184
    v_exp_f32 v185, v185
    v_exp_f32 v186, v186
    v_exp_f32 v187, v187
    v_exp_f32 v188, v188
    v_exp_f32 v189, v189
    v_exp_f32 v190, v190
    v_exp_f32 v191, v191
    s_nop 0
    s_mov_b64 exec, s[80:81]
    v_cvt_pk_bf16_f32 v164, v184, v185
    v_cvt_pk_bf16_f32 v165, v186, v187
    v_cvt_pk_bf16_f32 v166, v188, v189
    v_cvt_pk_bf16_f32 v167, v190, v191
    s_mov_b64 exec, s[82:83]
    v_cvt_pk_bf16_f32 v168, v184, v185
    v_cvt_pk_bf16_f32 v169, v186, v187
    v_cvt_pk_bf16_f32 v170, v188, v189
    v_cvt_pk_bf16_f32 v171, v190, v191
    s_mov_b64 exec, s[84:85]
    v_cvt_pk_bf16_f32 v172, v184, v185
    v_cvt_pk_bf16_f32 v173, v186, v187
    v_cvt_pk_bf16_f32 v174, v188, v189
    v_cvt_pk_bf16_f32 v175, v190, v191
    s_mov_b64 exec, s[86:87]
    v_cvt_pk_bf16_f32 v176, v184, v185
    v_cvt_pk_bf16_f32 v177, v186, v187
    v_cvt_pk_bf16_f32 v178, v188, v189
    v_cvt_pk_bf16_f32 v179, v190, v191
    s_mov_b64 exec, -1
    s_cmp_lg_u32 s60, 0
    s_cbranch_scc1 L_PV
    s_waitcnt vmcnt(3)
    v_perm_b32 v36, v72, v68, s72
    v_perm_b32 v40, v72, v68, s73
    v_perm_b32 v44, v73, v69, s72
    v_perm_b32 v48, v73, v69, s73
    v_perm_b32 v52, v74, v70, s72
    v_perm_b32 v56, v74, v70, s73
    v_perm_b32 v60, v75, v71, s72
    v_perm_b32 v64, v75, v71, s73
    v_perm_b32 v37, v80, v76, s72
    v_perm_b32 v41, v80, v76, s73
    v_perm_b32 v45, v81, v77, s72
    v_perm_b32 v49, v81, v77, s73
    v_perm_b32 v53, v82, v78, s72
    v_perm_b32 v57, v82, v78, s73
    v_perm_b32 v61, v83, v79, s72
    v_perm_b32 v65, v83, v79, s73
    v_perm_b32 v38, v88, v84, s72
    v_perm_b32 v42, v88, v84, s73
    v_perm_b32 v46, v89, v85, s72
    v_perm_b32 v50, v89, v85, s73
    v_perm_b32 v54, v90, v86, s72
    v_perm_b32 v58, v90, v86, s73
    v_perm_b32 v62, v91, v87, s72
    v_perm_b32 v66, v91, v87, s73
    v_perm_b32 v39, v96, v92, s72
    v_perm_b32 v43, v96, v92, s73
    v_perm_b32 v47, v97, v93, s72
    v_perm_b32 v51, v97, v93, s73
    v_perm_b32 v55, v98, v94, s72
    v_perm_b32 v59, v98, v94, s73
    v_perm_b32 v63, v99, v95, s72
    v_perm_b32 v67, v99, v95, s73
    s_branch L_PV2
L_PV:
    s_waitcnt vmcnt(0)
L_PV2:
    s_nop 1
    v_mfma_f32_16x16x32_bf16 v[192:195], v[36:39], v[164:167], 0
    v_mfma_f32_16x16x32_bf16 v[196:199], v[52:55], v[164:167], 0
    v_mfma_f32_16x16x32_bf16 v[192:195], v[40:43], v[168:171], v[192:195]
    v_mfma_f32_16x16x32_bf16 v[196:199], v[56:59], v[168:171], v[196:199]
    v_mfma_f32_16x16x32_bf16 v[192:195], v[44:47], v[172:175], v[192:195]
    v_mfma_f32_16x16x32_bf16 v[196:199], v[60:63], v[172:175], v[196:199]
    v_mfma_f32_16x16x32_bf16 v[192:195], v[48:51], v[176:179], v[192:195]
    v_mfma_f32_16x16x32_bf16 v[196:199], v[64:67], v[176:179], v[196:199]
    v_mfma_f32_16x16x32_bf16 v[184:187], v[180:183], v[164:167], 0
    s_nop 5
    ds_write_b128 v233, v[192:195]
    ds_write_b128 v233, v[196:199] offset:1088
    s_mov_b64 exec, 15
    ds_write_b32 v236, v184 offset:128
    s_mov_b64 exec, -1
    s_waitcnt vmcnt(1) lgkmcnt(0)
    s_barrier
    s_cmp_gt_u32 s52, 4
    s_cbranch_scc1 L_P2_B2
    ds_read_b128 v[200:203], v235
    ds_read_b128 v[204:207], v235 offset:16
    s_cmp_eq_u32 s52, 4
    s_cbranch_scc1 L_P2_B
    ds_read2st64_b64 v[68:71], v234 offset0:0 offset1:5
    ds_read2st64_b64 v[72:75], v234 offset0:10 offset1:15
    ds_read2st64_b64 v[76:79], v234 offset0:20 offset1:25
    ds_read2st64_b64 v[80:83], v234 offset0:30 offset1:35
    s_waitcnt lgkmcnt(4)
    v_max3_f32 v208, v200, v201, v202
    v_max3_f32 v209, v203, v204, v205
    v_max3_f32 v208, v208, v206, v207
    v_max_f32 v208, v208, v209
    v_sub_f32 v200, v200, v208
    v_sub_f32 v201, v201, v208
    v_sub_f32 v202, v202, v208
    v_sub_f32 v203, v203, v208
    v_sub_f32 v204, v204, v208
    v_sub_f32 v205, v205, v208
    v_sub_f32 v206, v206, v208
    v_sub_f32 v207, v207, v208
    v_exp_f32 v200, v200
    v_exp_f32 v201, v201
    v_exp_f32 v202, v202
    v_exp_f32 v203, v203
    v_exp_f32 v204, v204
    v_exp_f32 v205, v205
    v_exp_f32 v206, v206
    v_exp_f32 v207, v207
    s_waitcnt lgkmcnt(0)
    v_mul_f32 v68, v68, v200
    v_mul_f32 v69, v69, v200
    v_fmac_f32 v68, v70, v201
    v_fmac_f32 v69, v71, v201
    v_fmac_f32 v68, v72, v202
    v_fmac_f32 v69, v73, v202
    v_fmac_f32 v68, v74, v203
    v_fmac_f32 v69, v75, v203
    v_fmac_f32 v68, v76, v204
    v_fmac_f32 v69, v77, v204
    v_fmac_f32 v68, v78, v205
    v_fmac_f32 v69, v79, v205
    v_fmac_f32 v68, v80, v206
    v_fmac_f32 v69, v81, v206
    v_fmac_f32 v68, v82, v207
    v_fmac_f32 v69, v83, v207
    v_cvt_pk_bf16_f32 v209, v68, v69
    v_min_u32 v209, -2, v209
    s_cmp_eq_u32 s61, 0
    s_cbranch_scc1 STS_12
    buffer_store_dword v209, v218, s[48:51], s58 offen offset:0
    s_branch STD_13
STS_12:
    buffer_store_dword v209, v218, s[48:51], s58 offen offset:0 sc1
STD_13:
    s_cmp_lg_u32 s60, 0
    s_cbranch_scc1 L_P3
    v_lshrrev_b32 v204, 5, v1
    v_lshlrev_b32 v204, 12, v204
    v_bfe_u32 v205, v1, 4, 1
    v_lshl_add_u32 v204, v205, 8, v204
    v_bfe_u32 v205, v1, 2, 2
    v_lshl_add_u32 v204, v205, 10, v204
    v_and_b32 v205, 3, v1
    v_lshlrev_b32 v205, 3, v205
    s_lshl_b32 s67, s52, 5
    v_add_u32 v205, s67, v205
    v_add_u32 v204, v204, v205
    ds_read_b64_tr_b16 v[116:117], v204 offset:16384
    ds_read_b64_tr_b16 v[118:119], v204 offset:16512
    ds_read_b64_tr_b16 v[120:121], v204 offset:24576
    ds_read_b64_tr_b16 v[122:123], v204 offset:24704
    ds_read_b64_tr_b16 v[124:125], v204 offset:16896
    ds_read_b64_tr_b16 v[126:127], v204 offset:17024
    ds_read_b64_tr_b16 v[128:129], v204 offset:25088
    ds_read_b64_tr_b16 v[130:131], v204 offset:25216
    v_and_b32 v251, 0xffff0000, v250
    v_lshlrev_b32 v250, 16, v250
    s_branch L_P3
L_P2_B:
    ds_read_b128 v[68:71], v235 offset:128
    ds_read_b128 v[72:75], v235 offset:144
    s_waitcnt lgkmcnt(2)
    v_max3_f32 v208, v200, v201, v202
    v_max3_f32 v209, v203, v204, v205
    v_max3_f32 v208, v208, v206, v207
    v_max_f32 v208, v208, v209
    v_sub_f32 v200, v200, v208
    v_sub_f32 v201, v201, v208
    v_sub_f32 v202, v202, v208
    v_sub_f32 v203, v203, v208
    v_sub_f32 v204, v204, v208
    v_sub_f32 v205, v205, v208
    v_sub_f32 v206, v206, v208
    v_sub_f32 v207, v207, v208
    v_exp_f32 v200, v200
    v_exp_f32 v201, v201
    v_exp_f32 v202, v202
    v_exp_f32 v203, v203
    v_exp_f32 v204, v204
    v_exp_f32 v205, v205
    v_exp_f32 v206, v206
    v_exp_f32 v207, v207
    s_waitcnt lgkmcnt(0)
    v_mul_f32 v209, v68, v200
    v_fmac_f32 v209, v69, v201
    v_fmac_f32 v209, v70, v202
    v_fmac_f32 v209, v71, v203
    v_fmac_f32 v209, v72, v204
    v_fmac_f32 v209, v73, v205
    v_fmac_f32 v209, v74, v206
    v_fmac_f32 v209, v75, v207
    s_mov_b64 exec, 15
    s_cmp_eq_u32 s61, 0
    s_cbranch_scc1 STS_14
    buffer_store_dwordx2 v[208:209], v218, s[48:51], s58 offen offset:0
    s_branch STD_15
STS_14:
    buffer_store_dwordx2 v[208:209], v218, s[48:51], s58 offen offset:0 sc1
STD_15:
    s_mov_b64 exec, -1
L_P2_B2:
L_P3:
    s_lshl_b32 s64, s55, 13
    s_lshl_b32 s65, s52, 10
    s_add_u32 s64, s64, s65
    s_add_u32 s64, s64, s58
    s_add_u32 s64, s64, 32768
    s_cmp_eq_u32 s52, 7
    s_cbranch_scc1 L_P3_W7
    s_mov_b32 s63, 0
POLL_16:
    buffer_load_dwordx4 v[148:151], v232, s[48:51], s64 offen sc1
    s_waitcnt vmcnt(0)
    v_max3_u32 v204, v148, v149, v150
    v_max_u32 v204, v204, v151
    v_cmp_eq_u32 vcc, -1, v204
    s_cbranch_vccz POLLD_17
    s_add_u32 s63, s63, 1
    s_cmp_lt_u32 s63, 131072
    s_cbranch_scc1 POLL_16
POLLD_17:
    ds_write_b128 v219, v[148:151]
    s_branch L_P3_BAR
L_P3_W7:
    s_lshl_b32 s65, s55, 8
    s_add_u32 s65, s65, s58
    s_add_u32 s65, s65, 8192
    v_and_b32 v209, 0xff, v232
    s_mov_b32 s63, 0
POLL_18:
    buffer_load_dwordx4 v[148:151], v232, s[48:51], s64 offen sc1
    buffer_load_dwordx4 v[152:155], v209, s[48:51], s65 offen sc1
    s_waitcnt vmcnt(0)
    v_max3_u32 v208, v148, v149, v150
    v_max3_u32 v208, v208, v151, v152
    v_max3_u32 v208, v208, v153, v154
    v_max_u32 v208, v208, v155
    v_cmp_eq_u32 vcc, -1, v208
    s_cbranch_vccz POLLD_19
    s_add_u32 s63, s63, 1
    s_cmp_lt_u32 s63, 131072
    s_cbranch_scc1 POLL_18
POLLD_19:
    ds_write_b128 v219, v[148:151]
    ds_write_b128 v209, v[152:155] offset:59776
L_P3_BAR:
    s_waitcnt lgkmcnt(0)
    s_barrier
    s_cmp_ge_u32 s52, 4
    s_cbranch_scc1 L_P5
    ds_read2_b64 v[200:203], v221 offset0:0 offset1:4
    ds_read_b128 v[68:71], v220 offset:0
    ds_read_b128 v[84:87], v220 offset:4352
    ds_read_b128 v[72:75], v220 offset:64
    ds_read_b128 v[88:91], v220 offset:4416
    ds_read_b128 v[76:79], v220 offset:128
    ds_read_b128 v[92:95], v220 offset:4480
    ds_read_b128 v[80:83], v220 offset:192
    ds_read_b128 v[96:99], v220 offset:4544
    s_waitcnt lgkmcnt(8)
    v_max_f32 v204, v200, v202
    s_nop 1
    v_max_f32_dpp v204, v204, v204 quad_perm:[1,0,3,2] row_mask:0xf bank_mask:0xf
    s_nop 1
    v_max_f32_dpp v204, v204, v204 quad_perm:[2,3,0,1] row_mask:0xf bank_mask:0xf
    v_sub_f32 v200, v200, v204
    v_sub_f32 v202, v202, v204
    v_exp_f32 v200, v200
    v_exp_f32 v202, v202
    s_waitcnt lgkmcnt(6)
    v_mfma_f32_16x16x32_bf16 v[184:187], v[116:119], v[68:71], 0
    v_mfma_f32_16x16x32_bf16 v[188:191], v[116:119], v[84:87], 0
    s_waitcnt lgkmcnt(4)
    v_mfma_f32_16x16x32_bf16 v[184:187], v[120:123], v[72:75], v[184:187]
    v_mfma_f32_16x16x32_bf16 v[188:191], v[120:123], v[88:91], v[188:191]
    s_waitcnt lgkmcnt(2)
    v_mfma_f32_16x16x32_bf16 v[184:187], v[124:127], v[76:79], v[184:187]
    v_mfma_f32_16x16x32_bf16 v[188:191], v[124:127], v[92:95], v[188:191]
    s_waitcnt lgkmcnt(0)
    v_mfma_f32_16x16x32_bf16 v[184:187], v[128:131], v[80:83], v[184:187]
    v_mfma_f32_16x16x32_bf16 v[188:191], v[128:131], v[96:99], v[188:191]
    v_mul_f32 v204, v200, v201
    v_fmac_f32 v204, v202, v203
    s_nop 1
    v_add_f32_dpp v204, v204, v204 quad_perm:[1,0,3,2] row_mask:0xf bank_mask:0xf
    s_nop 1
    v_add_f32_dpp v204, v204, v204 quad_perm:[2,3,0,1] row_mask:0xf bank_mask:0xf
    v_rcp_f32 v204, v204
    s_nop 0
    v_mul_f32 v200, v200, v204
    v_mul_f32 v202, v202, v204
    v_mul_f32 v184, v184, v200
    v_mul_f32 v185, v185, v200
    v_mul_f32 v186, v186, v200
    v_mul_f32 v187, v187, v200
    v_fmac_f32 v184, v188, v202
    v_fmac_f32 v185, v189, v202
    v_fmac_f32 v186, v190, v202
    v_fmac_f32 v187, v191, v202
    v_add_f32_dpp v184, v184, v184 quad_perm:[1,0,3,2] row_mask:0xf bank_mask:0xf
    v_add_f32_dpp v185, v185, v185 quad_perm:[1,0,3,2] row_mask:0xf bank_mask:0xf
    v_add_f32_dpp v186, v186, v186 quad_perm:[1,0,3,2] row_mask:0xf bank_mask:0xf
    v_add_f32_dpp v187, v187, v187 quad_perm:[1,0,3,2] row_mask:0xf bank_mask:0xf
    v_add_f32_dpp v184, v184, v184 quad_perm:[2,3,0,1] row_mask:0xf bank_mask:0xf
    v_add_f32_dpp v185, v185, v185 quad_perm:[2,3,0,1] row_mask:0xf bank_mask:0xf
    v_add_f32_dpp v186, v186, v186 quad_perm:[2,3,0,1] row_mask:0xf bank_mask:0xf
    v_add_f32_dpp v187, v187, v187 quad_perm:[2,3,0,1] row_mask:0xf bank_mask:0xf
    v_cvt_pk_bf16_f32 v208, v184, v185
    v_cvt_pk_bf16_f32 v209, v186, v187
    v_min_u32 v208, -2, v208
    v_min_u32 v209, -2, v209
    v_mov_b32 v210, v208
    v_mov_b32 v211, v209
    s_nop 1
    v_permlane16_swap_b32 v208, v210
    v_permlane16_swap_b32 v209, v211
    s_mov_b32 exec_lo, 0x1111
    s_mov_b32 exec_hi, 0x1111
    buffer_store_dwordx4 v[208:211], v222, s[48:51], s58 offen sc1
    s_mov_b64 exec, -1
    s_cmp_lg_u32 s60, 0
    s_cbranch_scc1 L_BP
    v_and_b32 v205, 3, v1
    v_lshlrev_b32 v205, 3, v205
    s_lshl_b32 s67, s52, 5
    v_add_u32 v205, s67, v205
    v_lshl_add_u32 v204, v254, 7, v205
    ds_read_b64_tr_b16 v[100:101], v204 offset:0
    ds_read_b64_tr_b16 v[102:103], v204 offset:512
    ds_read_b64_tr_b16 v[104:105], v204 offset:4096
    ds_read_b64_tr_b16 v[106:107], v204 offset:4608
    ds_read_b64_tr_b16 v[108:109], v204 offset:8192
    ds_read_b64_tr_b16 v[110:111], v204 offset:8704
    ds_read_b64_tr_b16 v[112:113], v204 offset:12288
    ds_read_b64_tr_b16 v[114:115], v204 offset:12800
    s_add_u32 s64, s57, 180224
    s_waitcnt lgkmcnt(0)
    v_mfma_f32_16x16x32_bf16 v[184:187], v[100:103], v[180:183], 0
    v_mfma_f32_16x16x32_bf16 v[184:187], v[104:107], v[180:183], v[184:187]
    v_mfma_f32_16x16x32_bf16 v[184:187], v[108:111], v[180:183], v[184:187]
    v_mfma_f32_16x16x32_bf16 v[184:187], v[112:115], v[180:183], v[184:187]
    s_nop 5
    s_mov_b32 exec_lo, 0x100010
    s_mov_b32 exec_hi, 0x100010
    s_cmp_eq_u32 s61, 0
    s_cbranch_scc1 STS_20
    buffer_store_dwordx4 v[184:187], v227, s[48:51], s64 offen offset:0
    s_branch STD_21
STS_20:
    buffer_store_dwordx4 v[184:187], v227, s[48:51], s64 offen offset:0 sc1
STD_21:
    s_mov_b64 exec, -1
    s_branch L_BP0
L_P5:
    s_cmp_lg_u32 s60, 0
    s_cbranch_scc1 L_P5b
    s_cmp_lt_u32 s52, 6
    s_cbranch_scc1 L_W1F
    v_lshrrev_b32 v211, 2, v1
    v_and_b32 v212, 3, v1
    v_lshlrev_b32 v212, 4, v212
    s_and_b32 s66, s52, 1
    v_lshl_add_u32 v213, v211, 10, v212
    s_mul_i32 s67, s53, 229376
    s_mul_i32 s65, s79, 98304
    s_add_u32 s67, s67, s65
    s_lshl_b32 s65, s66, 16
    s_add_u32 s67, s67, s65
    s_lshr_b32 s65, s54, 1
    s_lshl_b32 s65, s65, 6
    s_add_u32 s67, s67, s65
    s_lshl_b32 s64, s66, 12
    s_add_u32 s64, s64, 40960
    s_mov_b32 m0, s64
    s_add_u32 s64, s64, 1024
    buffer_load_dwordx4 v213, s[32:35], s67 offen nt lds
    s_add_u32 s67, s67, 16384
    s_mov_b32 m0, s64
    s_add_u32 s64, s64, 1024
    buffer_load_dwordx4 v213, s[32:35], s67 offen nt lds
    s_add_u32 s67, s67, 16384
    s_mov_b32 m0, s64
    s_add_u32 s64, s64, 1024
    buffer_load_dwordx4 v213, s[32:35], s67 offen nt lds
    s_add_u32 s67, s67, 16384
    s_mov_b32 m0, s64
    s_add_u32 s64, s64, 1024
    buffer_load_dwordx4 v213, s[32:35], s67 offen nt lds
    s_add_u32 s67, s67, 16384
    s_branch L_P5b
L_W1F:
    s_cmp_lg_u32 s60, 0
    s_cbranch_scc1 L_P5b
    v_and_b32 v205, 3, v1
    v_lshlrev_b32 v205, 3, v205
    v_lshl_add_u32 v204, v254, 6, v205
    s_and_b32 s67, s52, 1
    s_lshl_b32 s67, s67, 5
    s_and_b32 s64, s52, 2
    s_lshl_b32 s64, s64, 12
    s_add_u32 s67, s67, s64
    v_add_u32 v204, s67, v204
    ds_read_b64_tr_b16 v[100:101], v204 offset:32768
    ds_read_b64_tr_b16 v[102:103], v204 offset:33024
    ds_read_b64_tr_b16 v[104:105], v204 offset:34816
    ds_read_b64_tr_b16 v[106:107], v204 offset:35072
    ds_read_b64_tr_b16 v[108:109], v204 offset:36864
    ds_read_b64_tr_b16 v[110:111], v204 offset:37120
    ds_read_b64_tr_b16 v[112:113], v204 offset:38912
    ds_read_b64_tr_b16 v[114:115], v204 offset:39168
    s_cmp_ge_u32 s52, 6
    s_cbranch_scc1 L_P5b
    s_cmp_ge_u32 s54, 28
    s_cbranch_scc1 L_P5b
    s_waitcnt lgkmcnt(0)
    v_mfma_f32_16x16x32_bf16 v[184:187], v[100:103], v[180:183], 0
    v_mfma_f32_16x16x32_bf16 v[184:187], v[104:107], v[180:183], v[184:187]
    v_mfma_f32_16x16x32_bf16 v[184:187], v[108:111], v[180:183], v[184:187]
    v_mfma_f32_16x16x32_bf16 v[184:187], v[112:115], v[180:183], v[184:187]
    s_nop 5
    s_mov_b32 exec_lo, 0x100010
    s_mov_b32 exec_hi, 0x100010
    s_cmp_eq_u32 s61, 0
    s_cbranch_scc1 STS_22
    buffer_store_dwordx4 v[184:187], v227, s[48:51], s58 offen offset:0
    s_branch STD_23
STS_22:
    buffer_store_dwordx4 v[184:187], v227, s[48:51], s58 offen offset:0 sc1
STD_23:
    s_mov_b64 exec, -1
L_P5b:
    s_cmp_lg_u32 s60, 0
    s_cbranch_scc1 L_BP
    s_cmp_lg_u32 s52, 4
    s_cbranch_scc1 L_BP0
    v_and_b32 v204, 7, v1
    v_lshlrev_b32 v204, 2, v204
    s_mov_b32 s63, 0
L_GFLAG:
    buffer_load_dword v205, v204, s[44:47], 0 offen offset:128 sc1
    s_waitcnt vmcnt(0)
    v_cmp_eq_u32 vcc, 0, v205
    s_cbranch_vccz L_BP0
    s_add_u32 s63, s63, 1
    s_cmp_lt_u32 s63, 131072
    s_cbranch_scc1 L_GFLAG
L_BP0:
    v_and_b32 v243, 0xffff0000, v241
    v_lshlrev_b32 v242, 16, v241
    v_and_b32 v241, 0xffff0000, v240
    v_lshlrev_b32 v240, 16, v240
    v_and_b32 v247, 0xffff0000, v245
    v_lshlrev_b32 v246, 16, v245
    v_and_b32 v245, 0xffff0000, v244
    v_lshlrev_b32 v244, 16, v244
L_BP:
    v_and_b32 v202, 15, v1
    v_and_b32 v203, 1, v1
    v_lshlrev_b32 v203, 4, v203
    v_mov_b32 v204, 0x3f80
    v_lshlrev_b32 v204, v203, v204
    v_lshrrev_b32 v202, 1, v202
    v_cmp_eq_u32 vcc, 0, v202
    s_nop 1
    v_cndmask_b32 v148, 0, v204, vcc
    v_cmp_eq_u32 vcc, 1, v202
    s_nop 1
    v_cndmask_b32 v149, 0, v204, vcc
    v_cmp_eq_u32 vcc, 2, v202
    s_nop 1
    v_cndmask_b32 v150, 0, v204, vcc
    v_cmp_eq_u32 vcc, 3, v202
    s_nop 1
    v_cndmask_b32 v151, 0, v204, vcc
    s_cmp_ge_u32 s52, 4
    s_cbranch_scc1 L_BPB
    s_waitcnt vmcnt(0)
L_BPB:
    s_barrier
    s_mov_b32 s63, 0
POLL_24:
    s_add_u32 s64, s59, 65536
    buffer_load_dwordx4 v[68:71], v223, s[48:51], s64 offen sc1
    s_add_u32 s64, s64, 442368
    buffer_load_dwordx4 v[72:75], v223, s[48:51], s64 offen sc1
    s_add_u32 s64, s64, 442368
    buffer_load_dwordx4 v[76:79], v223, s[48:51], s64 offen sc1
    s_add_u32 s64, s64, 442368
    buffer_load_dwordx4 v[80:83], v223, s[48:51], s64 offen sc1
    s_waitcnt vmcnt(0)
    v_max3_u32 v200, v68, v69, v70
    v_max3_u32 v200, v200, v71, v72
    v_max3_u32 v200, v200, v73, v74
    v_max3_u32 v200, v200, v75, v76
    v_max3_u32 v200, v200, v77, v78
    v_max3_u32 v200, v200, v79, v80
    v_max3_u32 v200, v200, v81, v82
    v_max_u32 v200, v200, v83
    v_cmp_eq_u32 vcc, -1, v200
    s_cbranch_vccz POLLD_25
    s_add_u32 s63, s63, 1
    s_cmp_lt_u32 s63, 131072
    s_cbranch_scc1 POLL_24
POLLD_25:
    v_mfma_f32_16x16x32_bf16 v[184:187], v[148:151], v[68:71], 0
    v_mfma_f32_16x16x32_bf16 v[184:187], v[148:151], v[72:75], v[184:187]
    v_mfma_f32_16x16x32_bf16 v[184:187], v[148:151], v[76:79], v[184:187]
    v_mfma_f32_16x16x32_bf16 v[184:187], v[148:151], v[80:83], v[184:187]
    s_nop 7
    v_add_f32_dpp v184, v184, v184 row_ror:8 row_mask:0xf bank_mask:0xf
    v_add_f32_dpp v185, v185, v185 row_ror:8 row_mask:0xf bank_mask:0xf
    v_add_f32_dpp v186, v186, v186 row_ror:8 row_mask:0xf bank_mask:0xf
    v_add_f32_dpp v187, v187, v187 row_ror:8 row_mask:0xf bank_mask:0xf
    v_cvt_pk_bf16_f32 v200, v184, v185
    v_cvt_pk_bf16_f32 v201, v186, v187
    v_lshlrev_b32 v184, 16, v200
    v_and_b32 v185, 0xffff0000, v200
    v_lshlrev_b32 v186, 16, v201
    v_and_b32 v187, 0xffff0000, v201
    v_pk_add_f32 v[184:185], v[184:185], v[240:241]
    v_pk_add_f32 v[186:187], v[186:187], v[242:243]
    v_cvt_pk_bf16_f32 v200, v184, v185
    v_cvt_pk_bf16_f32 v201, v186, v187
    v_min_u32 v200, -2, v200
    v_min_u32 v201, -2, v201
    s_mov_b32 exec_lo, 0xff00ff
    s_mov_b32 exec_hi, 0x0
    ds_write_b64 v226, v[200:201] offset:61056
    s_lshr_b32 s67, s54, 2
    s_cmp_lg_u32 s67, s52
    s_cbranch_scc1 NOPUB_26
    s_cmp_eq_u32 s61, 0
    s_cbranch_scc1 STS_27
    buffer_store_dwordx2 v[200:201], v226, s[48:51], s58 offen offset:0
    s_branch STD_28
STS_27:
    buffer_store_dwordx2 v[200:201], v226, s[48:51], s58 offen offset:0 sc1
STD_28:
NOPUB_26:
    s_mov_b64 exec, -1
    v_and_b32 v243, 0xffff0000, v201
    v_lshlrev_b32 v242, 16, v201
    v_and_b32 v241, 0xffff0000, v200
    v_lshlrev_b32 v240, 16, v200
    s_waitcnt lgkmcnt(0)
    s_barrier
    s_cmp_lt_u32 s52, 4
    s_cbranch_scc1 L_HSUM
    s_cmp_lt_u32 s52, 6
    s_cbranch_scc1 L_FR_D
    s_cmp_lg_u32 s60, 0
    s_cbranch_scc1 L_FR_D
    v_and_b32 v205, 3, v1
    v_lshlrev_b32 v205, 3, v205
    v_lshl_add_u32 v204, v254, 6, v205
    s_and_b32 s67, s52, 1
    s_lshl_b32 s67, s67, 5
    s_and_b32 s64, s52, 2
    s_lshl_b32 s64, s64, 12
    s_add_u32 s67, s67, s64
    v_add_u32 v204, s67, v204
    ds_read_b64_tr_b16 v[100:101], v204 offset:32768
    ds_read_b64_tr_b16 v[102:103], v204 offset:33024
    ds_read_b64_tr_b16 v[104:105], v204 offset:34816
    ds_read_b64_tr_b16 v[106:107], v204 offset:35072
    ds_read_b64_tr_b16 v[108:109], v204 offset:36864
    ds_read_b64_tr_b16 v[110:111], v204 offset:37120
    ds_read_b64_tr_b16 v[112:113], v204 offset:38912
    ds_read_b64_tr_b16 v[114:115], v204 offset:39168
L_FR_D:
    s_cmp_ge_u32 s52, 6
    s_cbranch_scc1 L_CSQ
    s_cmp_ge_u32 s54, 28
    s_cbranch_scc1 L_CSQ
    ds_read_b128 v[132:135], v217 offset:61056
    ds_read_b128 v[136:139], v217 offset:61312
    ds_read_b128 v[140:143], v217 offset:61568
    ds_read_b128 v[144:147], v217 offset:61824
    s_waitcnt lgkmcnt(3)
    v_mfma_f32_16x16x32_bf16 v[184:187], v[100:103], v[132:135], 0
    s_waitcnt lgkmcnt(2)
    v_mfma_f32_16x16x32_bf16 v[184:187], v[104:107], v[136:139], v[184:187]
    s_waitcnt lgkmcnt(1)
    v_mfma_f32_16x16x32_bf16 v[184:187], v[108:111], v[140:143], v[184:187]
    s_waitcnt lgkmcnt(0)
    v_mfma_f32_16x16x32_bf16 v[184:187], v[112:115], v[144:147], v[184:187]
    s_nop 5
    s_mov_b64 exec, s[80:81]
    s_cmp_eq_u32 s61, 0
    s_cbranch_scc1 STS_29
    buffer_store_dwordx4 v[184:187], v227, s[48:51], s58 offen offset:0
    s_branch STD_30
STS_29:
    buffer_store_dwordx4 v[184:187], v227, s[48:51], s58 offen offset:0 sc1
STD_30:
    s_mov_b64 exec, -1
L_CSQ:
    s_cmp_lg_u32 s60, 0
    s_cbranch_scc1 L_BARH
    s_add_u32 s64, s57, 180224
    s_lshl_b32 s67, s55, 11
    s_sub_u32 s67, 8192, s67
    v_add_u32 v203, s67, v228
    s_mov_b32 s63, 0
POLL_31:
    s_mov_b32 s65, s64
    buffer_load_dwordx2 v[68:69], v203, s[48:51], s65 offen sc1
    s_add_u32 s65, s65, 10240
    buffer_load_dwordx2 v[70:71], v203, s[48:51], s65 offen sc1
    s_add_u32 s65, s65, 10240
    buffer_load_dwordx2 v[72:73], v203, s[48:51], s65 offen sc1
    s_add_u32 s65, s65, 10240
    buffer_load_dwordx2 v[74:75], v203, s[48:51], s65 offen sc1
    s_waitcnt vmcnt(0)
    v_max3_u32 v202, v68, v69, v70
    v_max3_u32 v202, v202, v71, v72
    v_max3_u32 v202, v202, v73, v74
    v_max_u32 v202, v202, v75
    v_cmp_eq_u32 vcc, -1, v202
    s_cbranch_vccz POLLD_32
    s_add_u32 s63, s63, 1
    s_cmp_lt_u32 s63, 131072
    s_cbranch_scc1 POLL_31
POLLD_32:
    v_pk_add_f32 v[68:69], v[68:69], v[70:71]
    v_pk_add_f32 v[72:73], v[72:73], v[74:75]
    v_pk_add_f32 v[248:249], v[68:69], v[72:73]
    s_branch L_BARH
L_HSUM:
    s_add_u32 s64, s58, 12288
    s_cmp_lg_u32 s60, 0
    s_cbranch_scc1 L_HS1
    s_lshl_b32 s67, s52, 10
    s_sub_u32 s67, 4096, s67
    v_add_u32 v203, s67, v228
    s_mov_b32 s65, s64
    buffer_load_dwordx2 v[88:89], v203, s[48:51], s65 offen sc1
    s_add_u32 s65, s65, 5120
    buffer_load_dwordx2 v[90:91], v203, s[48:51], s65 offen sc1
    s_add_u32 s65, s65, 5120
    buffer_load_dwordx2 v[92:93], v203, s[48:51], s65 offen sc1
    s_add_u32 s65, s65, 5120
    buffer_load_dwordx2 v[94:95], v203, s[48:51], s65 offen sc1
L_HS1:
    v_mov_b32 v204, 0
    v_mov_b32 v208, 0
    s_mov_b32 s63, 0
POLL_33:
    buffer_load_dwordx4 v[148:151], v230, s[48:51], s58 offen sc1
    s_waitcnt vmcnt(0)
    v_max3_u32 v205, v148, v149, v150
    v_max_u32 v205, v205, v151
    v_cmp_eq_u32 vcc, -1, v205
    s_cbranch_vccz POLLD_34
    s_add_u32 s63, s63, 1
    s_cmp_lt_u32 s63, 131072
    s_cbranch_scc1 POLL_33
POLLD_34:
    s_mov_b32 s65, s64
    buffer_load_dwordx2 v[68:69], v228, s[48:51], s65 offen sc1
    s_add_u32 s65, s65, 5120
    buffer_load_dwordx2 v[70:71], v228, s[48:51], s65 offen sc1
    s_add_u32 s65, s65, 5120
    buffer_load_dwordx2 v[72:73], v228, s[48:51], s65 offen sc1
    s_add_u32 s65, s65, 5120
    buffer_load_dwordx2 v[74:75], v228, s[48:51], s65 offen sc1
    v_dot2c_f32_bf16 v204, v148, v148
    v_dot2c_f32_bf16 v208, v148, v180
    v_dot2c_f32_bf16 v204, v149, v149
    v_dot2c_f32_bf16 v208, v149, v180
    v_dot2c_f32_bf16 v204, v150, v150
    v_dot2c_f32_bf16 v208, v150, v180
    v_dot2c_f32_bf16 v204, v151, v151
    v_dot2c_f32_bf16 v208, v151, v180
    s_nop 2
    v_add_f32_dpp v204, v204, v204 quad_perm:[1,0,3,2] row_mask:0xf bank_mask:0xf
    v_add_f32_dpp v208, v208, v208 quad_perm:[1,0,3,2] row_mask:0xf bank_mask:0xf
    s_nop 0
    v_add_f32_dpp v204, v204, v204 quad_perm:[2,3,0,1] row_mask:0xf bank_mask:0xf
    v_add_f32_dpp v208, v208, v208 quad_perm:[2,3,0,1] row_mask:0xf bank_mask:0xf
    s_nop 0
    v_add_f32_dpp v204, v204, v204 row_half_mirror row_mask:0xf bank_mask:0xf
    v_add_f32_dpp v208, v208, v208 row_half_mirror row_mask:0xf bank_mask:0xf
    s_nop 0
    v_add_f32_dpp v204, v204, v204 row_mirror row_mask:0xf bank_mask:0xf
    v_add_f32_dpp v208, v208, v208 row_mirror row_mask:0xf bank_mask:0xf
    s_nop 0
    v_mov_b32 v205, v204
    v_mov_b32 v209, v208
    s_nop 0
    v_permlane16_swap_b32 v204, v205
    v_permlane16_swap_b32 v208, v209
    s_nop 0
    v_add_f32 v204, v204, v205
    v_add_f32 v208, v208, v209
    v_mov_b32 v205, v204
    v_mov_b32 v209, v208
    s_nop 0
    v_permlane32_swap_b32 v204, v205
    v_permlane32_swap_b32 v208, v209
    s_nop 0
    v_add_f32 v204, v204, v205
    v_add_f32 v208, v208, v209
    v_mul_f32 v208, 0x3b000000, v208
    v_mul_f32 v204, 0x3b000000, v204
    v_fma_f32 v204, -v208, v208, v204
    v_max_f32 v204, 0, v204
    v_add_f32 v205, 0x3727c5ac, v204
    v_rsq_f32 v205, v205
    s_nop 0
    v_mul_f32 v204, v204, v205
    v_mul_f32 v204, v204, v205
    v_add_f32 v204, 0x3727c5ac, v204
    v_rsq_f32 v204, v204
    s_nop 0
    v_mul_f32 v204, v204, v205
    s_cmp_lg_u32 s60, 0
    s_cbranch_scc1 CSL_35
    v_max3_u32 v202, v88, v89, v90
    v_max3_u32 v202, v202, v91, v92
    v_max3_u32 v202, v202, v93, v94
    v_max_u32 v202, v202, v95
    v_cmp_eq_u32 vcc, -1, v202
    s_cbranch_vccz CSO_36
    s_mov_b32 s63, 0
POLL_37:
    s_mov_b32 s65, s64
    buffer_load_dwordx2 v[88:89], v203, s[48:51], s65 offen sc1
    s_add_u32 s65, s65, 5120
    buffer_load_dwordx2 v[90:91], v203, s[48:51], s65 offen sc1
    s_add_u32 s65, s65, 5120
    buffer_load_dwordx2 v[92:93], v203, s[48:51], s65 offen sc1
    s_add_u32 s65, s65, 5120
    buffer_load_dwordx2 v[94:95], v203, s[48:51], s65 offen sc1
    s_waitcnt vmcnt(0)
    v_max3_u32 v202, v88, v89, v90
    v_max3_u32 v202, v202, v91, v92
    v_max3_u32 v202, v202, v93, v94
    v_max_u32 v202, v202, v95
    v_cmp_eq_u32 vcc, -1, v202
    s_cbranch_vccz POLLD_38
    s_add_u32 s63, s63, 1
    s_cmp_lt_u32 s63, 131072
    s_cbranch_scc1 POLL_37
POLLD_38:
CSO_36:
    v_pk_add_f32 v[88:89], v[88:89], v[90:91]
    v_pk_add_f32 v[92:93], v[92:93], v[94:95]
    v_pk_add_f32 v[248:249], v[88:89], v[92:93]
CSL_35:
    v_mul_f32 v206, v208, v248
    v_mul_f32 v207, v208, v249
    s_waitcnt vmcnt(0)
    v_max3_u32 v202, v68, v69, v70
    v_max3_u32 v202, v202, v71, v72
    v_max3_u32 v202, v202, v73, v74
    v_max_u32 v202, v202, v75
    v_cmp_eq_u32 vcc, -1, v202
    s_cbranch_vccz SPD_39
    s_mov_b32 s63, 0
POLL_40:
    s_mov_b32 s65, s64
    buffer_load_dwordx2 v[68:69], v228, s[48:51], s65 offen sc1
    s_add_u32 s65, s65, 5120
    buffer_load_dwordx2 v[70:71], v228, s[48:51], s65 offen sc1
    s_add_u32 s65, s65, 5120
    buffer_load_dwordx2 v[72:73], v228, s[48:51], s65 offen sc1
    s_add_u32 s65, s65, 5120
    buffer_load_dwordx2 v[74:75], v228, s[48:51], s65 offen sc1
    s_waitcnt vmcnt(0)
    v_max3_u32 v202, v68, v69, v70
    v_max3_u32 v202, v202, v71, v72
    v_max3_u32 v202, v202, v73, v74
    v_max_u32 v202, v202, v75
    v_cmp_eq_u32 vcc, -1, v202
    s_cbranch_vccz POLLD_41
    s_add_u32 s63, s63, 1
    s_cmp_lt_u32 s63, 131072
    s_cbranch_scc1 POLL_40
POLLD_41:
SPD_39:
    v_pk_add_f32 v[84:85], v[68:69], v[70:71]
    v_pk_add_f32 v[86:87], v[72:73], v[74:75]
    v_pk_add_f32 v[84:85], v[84:85], v[206:207] neg_lo:[0,1] neg_hi:[0,1]
    v_pk_add_f32 v[84:85], v[84:85], v[86:87]
    v_mul_f32 v200, v84, v204
    v_mul_f32 v201, v85, v204
    v_add_f32 v200, v200, v250
    v_add_f32 v201, v201, v251
    v_mul_f32 v202, v200, v200
    v_mul_f32 v203, v201, v201
    v_mov_b32 v204, 0xc0135761
    v_fmac_f32 v204, 0xbdd2d3e8, v202
    v_mov_b32 v205, 0xc0135761
    v_fmac_f32 v205, 0xbdd2d3e8, v203
    v_mul_f32 v204, v204, v200
    v_mul_f32 v205, v205, v201
    v_exp_f32 v204, v204
    v_exp_f32 v205, v205
    s_nop 0
    v_add_f32 v204, 1.0, v204
    v_add_f32 v205, 1.0, v205
    v_rcp_f32 v204, v204
    v_rcp_f32 v205, v205
    s_nop 0
    v_mul_f32 v200, v200, v204
    v_mul_f32 v201, v201, v205
    v_cvt_pk_bf16_f32 v200, v200, v201
    ds_write_b32 v229, v200
    s_waitcnt lgkmcnt(0)
L_BARH:
    s_barrier
    s_cmp_lt_u32 s52, 6
    s_cbranch_scc1 L_BP2
    ds_read_b128 v[68:71], v231 offset:0
    ds_read_b128 v[72:75], v231 offset:64
    ds_read_b128 v[76:79], v231 offset:128
    ds_read_b128 v[80:83], v231 offset:192
    s_waitcnt lgkmcnt(2)
    v_mfma_f32_16x16x32_bf16 v[184:187], v[104:107], v[72:75], 0
    s_waitcnt lgkmcnt(1)
    v_mfma_f32_16x16x32_bf16 v[184:187], v[108:111], v[76:79], v[184:187]
    s_waitcnt lgkmcnt(0)
    v_mfma_f32_16x16x32_bf16 v[184:187], v[112:115], v[80:83], v[184:187]
    s_cmp_lg_u32 s79, 0
    s_cbranch_scc1 L_P6_S
    v_mfma_f32_16x16x32_bf16 v[184:187], v[100:103], v[68:71], v[184:187]
L_P6_S:
    s_nop 7
    v_cvt_pk_bf16_f32 v208, v184, v185
    v_cvt_pk_bf16_f32 v209, v186, v187
    v_min_u32 v208, -2, v208
    v_min_u32 v209, -2, v209
    v_mov_b32 v210, v208
    v_mov_b32 v211, v209
    s_nop 1
    v_permlane16_swap_b32 v208, v210
    v_permlane16_swap_b32 v209, v211
    s_mov_b32 exec_lo, 0xf
    s_mov_b32 exec_hi, 0xf
    buffer_store_dwordx4 v[208:211], v227, s[48:51], s58 offen sc1
    s_mov_b64 exec, -1
L_BP2:
    v_and_b32 v202, 15, v1
    v_and_b32 v203, 1, v1
    v_lshlrev_b32 v203, 4, v203
    v_mov_b32 v204, 0x3f80
    v_lshlrev_b32 v204, v203, v204
    v_lshrrev_b32 v202, 1, v202
    v_cmp_eq_u32 vcc, 0, v202
    s_nop 1
    v_cndmask_b32 v148, 0, v204, vcc
    v_cmp_eq_u32 vcc, 1, v202
    s_nop 1
    v_cndmask_b32 v149, 0, v204, vcc
    v_cmp_eq_u32 vcc, 2, v202
    s_nop 1
    v_cndmask_b32 v150, 0, v204, vcc
    v_cmp_eq_u32 vcc, 3, v202
    s_nop 1
    v_cndmask_b32 v151, 0, v204, vcc
    s_waitcnt vmcnt(0)
    s_barrier
    s_cmp_eq_u32 s60, 0
    s_cbranch_scc1 L_P7_GO
    s_lshr_b32 s67, s54, 2
    s_cmp_lg_u32 s67, s52
    s_cbranch_scc1 L_END
    s_cmp_lg_u32 s52, s53
    s_cbranch_scc1 L_END
L_P7_GO:
    s_mov_b32 s63, 0
POLL_42:
    s_add_u32 s64, s59, 81920
    buffer_load_dwordx4 v[68:71], v224, s[48:51], s64 offen sc1
    s_add_u32 s64, s64, 884736
    buffer_load_dwordx4 v[72:75], v224, s[48:51], s64 offen sc1
    s_waitcnt vmcnt(0)
    v_max3_u32 v200, v68, v69, v70
    v_max3_u32 v200, v200, v71, v72
    v_max3_u32 v200, v200, v73, v74
    v_max_u32 v200, v200, v75
    v_cmp_eq_u32 vcc, -1, v200
    s_cbranch_vccz POLLD_43
    s_add_u32 s63, s63, 1
    s_cmp_lt_u32 s63, 131072
    s_cbranch_scc1 POLL_42
POLLD_43:
    v_mfma_f32_16x16x32_bf16 v[184:187], v[148:151], v[68:71], 0
    v_mfma_f32_16x16x32_bf16 v[184:187], v[148:151], v[72:75], v[184:187]
    s_nop 7
    v_add_f32_dpp v184, v184, v184 row_ror:8 row_mask:0xf bank_mask:0xf
    v_add_f32_dpp v185, v185, v185 row_ror:8 row_mask:0xf bank_mask:0xf
    v_add_f32_dpp v186, v186, v186 row_ror:8 row_mask:0xf bank_mask:0xf
    v_add_f32_dpp v187, v187, v187 row_ror:8 row_mask:0xf bank_mask:0xf
    v_pk_add_f32 v[184:185], v[184:185], v[244:245]
    v_pk_add_f32 v[186:187], v[186:187], v[246:247]
    v_cvt_pk_bf16_f32 v200, v184, v185
    v_cvt_pk_bf16_f32 v201, v186, v187
    v_lshlrev_b32 v184, 16, v200
    v_and_b32 v185, 0xffff0000, v200
    v_lshlrev_b32 v186, 16, v201
    v_and_b32 v187, 0xffff0000, v201
    v_pk_add_f32 v[184:185], v[184:185], v[240:241]
    v_pk_add_f32 v[186:187], v[186:187], v[242:243]
    v_cvt_pk_bf16_f32 v200, v184, v185
    v_cvt_pk_bf16_f32 v201, v186, v187
    v_min_u32 v200, -2, v200
    v_min_u32 v201, -2, v201
    s_cmp_eq_u32 s60, 0
    s_cbranch_scc1 L_P7_MID
    s_mov_b32 exec_lo, 0xff00ff
    s_mov_b32 exec_hi, 0x0
    buffer_store_dwordx2 v[200:201], v225, s[40:43], 0 offen
    s_cmp_lg_u32 s2, 0
    s_cbranch_scc1 L_NOCLEAN
    s_mov_b64 exec, -1
    v_mov_b32 v202, 0
    buffer_store_dword v202, v3, s[44:47], 0 offen sc1
L_NOCLEAN:
    s_branch L_END
L_P7_MID:
    s_add_u32 s66, s58, 4096
    s_mov_b32 exec_lo, 0xff00ff
    s_mov_b32 exec_hi, 0x0
    ds_write_b64 v226, v[200:201] offset:61056
    s_lshr_b32 s67, s54, 2
    s_cmp_lg_u32 s67, s52
    s_cbranch_scc1 NOPUB_44
    s_cmp_eq_u32 s61, 0
    s_cbranch_scc1 STS_45
    buffer_store_dwordx2 v[200:201], v226, s[48:51], s66 offen offset:0
    s_branch STD_46
STS_45:
    buffer_store_dwordx2 v[200:201], v226, s[48:51], s66 offen offset:0 sc1
STD_46:
NOPUB_44:
    s_mov_b64 exec, -1
    v_and_b32 v243, 0xffff0000, v201
    v_lshlrev_b32 v242, 16, v201
    v_and_b32 v241, 0xffff0000, v200
    v_lshlrev_b32 v240, 16, v200
    s_waitcnt lgkmcnt(0)
    s_mov_b32 s60, 1
    s_add_u32 s58, s58, 90112
    s_mov_b32 s59, 90112
    s_barrier
    s_add_u32 s64, s57, 180224
    s_cmp_ge_u32 s52, 4
    s_cbranch_scc1 L_QSUM
    ds_read_b128 v[132:135], v217 offset:61056
    ds_read_b128 v[136:139], v217 offset:61312
    ds_read_b128 v[140:143], v217 offset:61568
    ds_read_b128 v[144:147], v217 offset:61824
    s_waitcnt lgkmcnt(3)
    v_mfma_f32_16x16x32_bf16 v[184:187], v[100:103], v[132:135], 0
    s_waitcnt lgkmcnt(2)
    v_mfma_f32_16x16x32_bf16 v[184:187], v[104:107], v[136:139], v[184:187]
    s_waitcnt lgkmcnt(1)
    v_mfma_f32_16x16x32_bf16 v[184:187], v[108:111], v[140:143], v[184:187]
    s_waitcnt lgkmcnt(0)
    v_mfma_f32_16x16x32_bf16 v[184:187], v[112:115], v[144:147], v[184:187]
    s_nop 5
    s_mov_b64 exec, s[80:81]
    s_cmp_eq_u32 s61, 0
    s_cbranch_scc1 STS_47
    buffer_store_dwordx4 v[184:187], v227, s[48:51], s64 offen offset:0
    s_branch STD_48
STS_47:
    buffer_store_dwordx4 v[184:187], v227, s[48:51], s64 offen offset:0 sc1
STD_48:
    s_mov_b64 exec, -1
    s_branch L_QBAR
L_QSUM:
    v_mov_b32 v204, 0
    v_mov_b32 v208, 0
    s_mov_b32 s63, 0
POLL_49:
    buffer_load_dwordx4 v[148:151], v230, s[48:51], s66 offen sc1
    s_waitcnt vmcnt(0)
    v_max3_u32 v205, v148, v149, v150
    v_max_u32 v205, v205, v151
    v_cmp_eq_u32 vcc, -1, v205
    s_cbranch_vccz POLLD_50
    s_add_u32 s63, s63, 1
    s_cmp_lt_u32 s63, 131072
    s_cbranch_scc1 POLL_49
POLLD_50:
    s_mov_b32 s65, s64
    buffer_load_dwordx2 v[68:69], v228, s[48:51], s65 offen sc1
    s_add_u32 s65, s65, 10240
    buffer_load_dwordx2 v[70:71], v228, s[48:51], s65 offen sc1
    s_add_u32 s65, s65, 10240
    buffer_load_dwordx2 v[72:73], v228, s[48:51], s65 offen sc1
    s_add_u32 s65, s65, 10240
    buffer_load_dwordx2 v[74:75], v228, s[48:51], s65 offen sc1
    v_dot2c_f32_bf16 v204, v148, v148
    v_dot2c_f32_bf16 v208, v148, v180
    v_dot2c_f32_bf16 v204, v149, v149
    v_dot2c_f32_bf16 v208, v149, v180
    v_dot2c_f32_bf16 v204, v150, v150
    v_dot2c_f32_bf16 v208, v150, v180
    v_dot2c_f32_bf16 v204, v151, v151
    v_dot2c_f32_bf16 v208, v151, v180
    s_nop 2
    v_add_f32_dpp v204, v204, v204 quad_perm:[1,0,3,2] row_mask:0xf bank_mask:0xf
    v_add_f32_dpp v208, v208, v208 quad_perm:[1,0,3,2] row_mask:0xf bank_mask:0xf
    s_nop 0
    v_add_f32_dpp v204, v204, v204 quad_perm:[2,3,0,1] row_mask:0xf bank_mask:0xf
    v_add_f32_dpp v208, v208, v208 quad_perm:[2,3,0,1] row_mask:0xf bank_mask:0xf
    s_nop 0
    v_add_f32_dpp v204, v204, v204 row_half_mirror row_mask:0xf bank_mask:0xf
    v_add_f32_dpp v208, v208, v208 row_half_mirror row_mask:0xf bank_mask:0xf
    s_nop 0
    v_add_f32_dpp v204, v204, v204 row_mirror row_mask:0xf bank_mask:0xf
    v_add_f32_dpp v208, v208, v208 row_mirror row_mask:0xf bank_mask:0xf
    s_nop 0
    v_mov_b32 v205, v204
    v_mov_b32 v209, v208
    s_nop 0
    v_permlane16_swap_b32 v204, v205
    v_permlane16_swap_b32 v208, v209
    s_nop 0
    v_add_f32 v204, v204, v205
    v_add_f32 v208, v208, v209
    v_mov_b32 v205, v204
    v_mov_b32 v209, v208
    s_nop 0
    v_permlane32_swap_b32 v204, v205
    v_permlane32_swap_b32 v208, v209
    s_nop 0
    v_add_f32 v204, v204, v205
    v_add_f32 v208, v208, v209
    v_mul_f32 v208, 0x3b000000, v208
    v_mul_f32 v204, 0x3b000000, v204
    v_fma_f32 v204, -v208, v208, v204
    v_max_f32 v204, 0, v204
    v_add_f32 v205, 0x3727c5ac, v204
    v_rsq_f32 v205, v205
    s_nop 0
    v_mov_b32 v204, v205
    v_mul_f32 v206, v208, v248
    v_mul_f32 v207, v208, v249
    s_waitcnt vmcnt(0)
    v_max3_u32 v202, v68, v69, v70
    v_max3_u32 v202, v202, v71, v72
    v_max3_u32 v202, v202, v73, v74
    v_max_u32 v202, v202, v75
    v_cmp_eq_u32 vcc, -1, v202
    s_cbranch_vccz SPD_51
    s_mov_b32 s63, 0
POLL_52:
    s_mov_b32 s65, s64
    buffer_load_dwordx2 v[68:69], v228, s[48:51], s65 offen sc1
    s_add_u32 s65, s65, 10240
    buffer_load_dwordx2 v[70:71], v228, s[48:51], s65 offen sc1
    s_add_u32 s65, s65, 10240
    buffer_load_dwordx2 v[72:73], v228, s[48:51], s65 offen sc1
    s_add_u32 s65, s65, 10240
    buffer_load_dwordx2 v[74:75], v228, s[48:51], s65 offen sc1
    s_waitcnt vmcnt(0)
    v_max3_u32 v202, v68, v69, v70
    v_max3_u32 v202, v202, v71, v72
    v_max3_u32 v202, v202, v73, v74
    v_max_u32 v202, v202, v75
    v_cmp_eq_u32 vcc, -1, v202
    s_cbranch_vccz POLLD_53
    s_add_u32 s63, s63, 1
    s_cmp_lt_u32 s63, 131072
    s_cbranch_scc1 POLL_52
POLLD_53:
SPD_51:
    v_pk_add_f32 v[84:85], v[68:69], v[70:71]
    v_pk_add_f32 v[86:87], v[72:73], v[74:75]
    v_pk_add_f32 v[84:85], v[84:85], v[206:207] neg_lo:[0,1] neg_hi:[0,1]
    v_pk_add_f32 v[84:85], v[84:85], v[86:87]
    v_mul_f32 v200, v84, v204
    v_mul_f32 v201, v85, v204
    v_cvt_pk_bf16_f32 v200, v200, v201
    ds_write_b32 v229, v200
    s_waitcnt lgkmcnt(0)
L_QBAR:
    s_barrier
    s_branch L_LOOP
L_END:
    s_endpgm
.fill (16384 - (. - interleave_layers__sliding_block_cached__mixer_channel_mlp__decode_kernel)) / 4, 4, 0xbf800000
.section .rodata,"a"
.p2align 6
.amdhsa_kernel interleave_layers__sliding_block_cached__mixer_channel_mlp__decode_kernel
  .amdhsa_next_free_vgpr 256
  .amdhsa_next_free_sgpr 102
  .amdhsa_accum_offset 256
  .amdhsa_group_segment_fixed_size 0
  .amdhsa_kernarg_size 104
  .amdhsa_user_sgpr_count 2
  .amdhsa_user_sgpr_kernarg_segment_ptr 1
  .amdhsa_system_sgpr_workgroup_id_x 1
.end_amdhsa_kernel
```
